```python
import torch

def _softmax(x, axis=-1):
    return torch.softmax(x, dim=axis)
def _gelu(x):
    return torch.nn.functional.gelu(x, approximate="tanh")
def _silu(x):
    return torch.nn.functional.silu(x)
def _sigmoid(x):
    return torch.sigmoid(x)
def _layernorm(x, axis=-1, eps=1e-5):
    m = x.mean(dim=axis, keepdim=True)
    v = x.var(dim=axis, keepdim=True, unbiased=False)
    return (x - m) / torch.sqrt(v + eps)
def _scatter_add(tgt, idx, src, axis=0):
    return tgt.clone().index_add_(axis, idx, src)
def _segment_sum(src, seg, n):
    out = torch.zeros((n,) + src.shape[1:], dtype=src.dtype)
    return out.index_add_(0, seg, src)
def _pad(x, pw):
    flat = tuple(v for pair in reversed(pw) for v in pair)
    return torch.nn.functional.pad(x, flat)

kernel_name = 'standalone__mha_block_cached__near_ridge'

def setup_inputs():

    _w = (lambda a: (lambda t: t.to(torch.bfloat16) if t.is_floating_point() else t)(torch.as_tensor(a)))
    B, Sq, D = 16, 112, 640
    H, Sk, Dh = 32, 512, 192
    return {
        "x": _w((lambda *s: torch.randn(*s, dtype=torch.bfloat16) * 0.8)(B, Sq, D)),
        "k_cache": _w((lambda *s: torch.randn(*s, dtype=torch.bfloat16) * 0.8)(B, H, Sk, Dh)),
        "v_cache": _w((lambda *s: torch.randn(*s, dtype=torch.bfloat16) * 0.05)(B, H, Sk, Dh)),
        "wq": _w((lambda *s: torch.randn(*s, dtype=torch.bfloat16) * 0.8)(D, H * Dh) * (D ** -0.5)),
        "wo": _w((lambda *s: torch.randn(*s, dtype=torch.bfloat16) * 0.05)(H * Dh, D) * ((H * Dh) ** -0.5)),
    }

def reference(x, k_cache, v_cache, wq, wo):
    B, Sq, D = x.shape
    H, Dh = 32, 192
    q = (lambda x, *d: x.permute(*d))((x @ wq).reshape(B, Sq, H, Dh), 0, 2, 1, 3)
    scores = torch.einsum("bhqd,bhkd->bhqk", q, k_cache) * (Dh ** -0.5)
    p = _softmax(scores, axis=-1)
    o = torch.einsum("bhqk,bhkd->bhqd", p, v_cache)
    return (lambda x, *d: x.permute(*d))(o, 0, 2, 1, 3).reshape(B, Sq, H * Dh) @ wo
```

```asm
; @launch grid=(256,1,1) block=(512,1,1) lds=163840
.amdgcn_target "amdgcn-amd-amdhsa--gfx950"
.text
.globl standalone__mha_block_cached__near_ridge_kernel
.p2align 8
.type standalone__mha_block_cached__near_ridge_kernel,@function
standalone__mha_block_cached__near_ridge_kernel:
  s_cmp_ge_u32 s2, 256
  s_cbranch_scc1 L_end
  s_load_dwordx2 s[16:17], s[0:1], 24
  s_load_dwordx2 s[4:5], s[0:1], 0
  v_lshrrev_b32 v25, 3, v0
  v_and_b32 v24, 7, v0
  v_mov_b32 v26, 0x40000000
  v_cmp_le_u32 vcc, 20, v25
  v_cmp_le_u32 s[60:61], 6, v24
  v_mul_u32_u24 v28, 12288, v25
  v_lshl_add_u32 v28, v24, 7, v28
  s_add_u32 s47, s2, 0
  s_and_b32 s47, s47, 7
  s_lshr_b32 s31, s2, 4
  s_bfe_u32 s32, s2, 0x10003
  s_lshl_b32 s47, s47, 1
  s_add_u32 s32, s32, s47
  s_or_b64 vcc, vcc, s[60:61]
  s_mul_i32 s47, s31, 245760
  s_mul_i32 s44, s32, 768
  s_add_u32 s44, s47, s44
  v_cndmask_b32 v28, v28, v26, vcc
  v_lshrrev_b32 v23, 6, v0
  v_cmp_le_u32 vcc, 48, v25
  v_bfe_u32 v3, v25, 1, 3
  v_readfirstlane_b32 s28, v23
  v_xor_b32 v3, v3, v24
  v_lshlrev_b32 v3, 4, v3
  v_mul_u32_u24 v5, 1280, v25
  v_add_u32 v5, v5, v3
  v_add_u32 v6, 81920, v5
  v_cndmask_b32 v6, v6, v26, vcc
  s_mul_i32 s38, s31, 143360
  s_lshl_b32 s49, s28, 10
  s_mov_b32 s18, 7864320
  s_mov_b32 s19, 0x00020000
  s_mov_b32 s6, 2293760
  s_mov_b32 s7, 0x00020000
  s_waitcnt lgkmcnt(0)
  buffer_load_dword v29, v28, s[16:19], s44 offen
  s_add_u32 m0, s49, 122880
  s_add_u32 s40, s38, 0
  buffer_load_dwordx4 v5, s[4:7], s40 offen  lds
  s_add_u32 m0, s49, 131072
  s_add_u32 s40, s38, 0
  buffer_load_dwordx4 v6, s[4:7], s40 offen  lds
  s_load_dwordx2 s[8:9], s[0:1], 8
  s_load_dwordx2 s[12:13], s[0:1], 16
  s_load_dwordx2 s[20:21], s[0:1], 32
  s_load_dwordx2 s[24:25], s[0:1], 56
  s_load_dwordx2 s[68:69], s[0:1], 40
  s_load_dwordx2 s[72:73], s[0:1], 48
  s_getpc_b64 s[62:63]
  s_lshr_b32 s47, s2, 3
  s_lshl_b32 s47, s47, 7
  v_lshrrev_b32 v27, 5, v0
  v_lshlrev_b32 v27, 12, v27
  v_add_u32 v27, s47, v27
  v_min_u32 v27, 38400, v27
  global_load_dword v29, v27, s[62:63]
  v_and_b32 v0, 63, v0
  v_cmp_le_u32 vcc, 30, v0
  s_mul_i32 s47, s28, 30
  v_add_u32 v25, s47, v0
  v_lshlrev_b32 v30, 7, v25
  v_cndmask_b32 v30, v30, v26, vcc
  s_lshr_b32 s29, s28, 2
  s_and_b32 s30, s28, 3
  s_mul_i32 s48, s29, 12288
  s_mul_i32 s33, s30, 3072
  s_add_u32 s33, s33, s48
  s_lshl_b32 s37, s32, 1
  s_add_u32 s37, s37, s29
  s_mul_i32 s36, s37, 384
  v_lshrrev_b32 v23, 3, v0
  v_bfe_u32 v27, v0, 4, 1
  s_and_b32 s47, s30, 1
  s_lshl_b32 s47, s47, 2
  v_lshl_or_b32 v4, v27, 1, s47
  v_xor_b32 v4, v4, v24
  v_lshlrev_b32 v4, 4, v4
  s_lshl_b32 s47, s30, 3
  v_add_u32 v2, s47, v23
  v_mul_u32_u24 v1, 12288, v2
  v_add_u32 v1, v1, v4
  s_mov_b32 s10, 100663296
  s_mov_b32 s11, 0x00020000
  s_mov_b32 s14, 100663296
  s_mov_b32 s15, 0x00020000
  s_mov_b32 s22, 7864320
  s_mov_b32 s23, 0x00020000
  s_mov_b32 s26, 36864000
  s_mov_b32 s27, 0x00020000
  s_mov_b32 s70, 2293760
  s_mov_b32 s71, 0x00020000
  s_mov_b32 s74, 256
  s_mov_b32 s75, 0x00020000
  v_bfe_u32 v27, v0, 4, 2
  v_lshlrev_b32 v27, 1, v27
  v_xor_b32 v27, v27, v24
  v_mul_u32_u24 v25, 1280, v2
  v_lshl_add_u32 v4, v27, 4, v25
  v_mul_u32_u24 v25, 384, v2
  v_add_u32 v2, v25, v3
  v_lshl_add_u32 v3, v27, 4, v25
  s_mov_b32 s34, s33
  s_add_u32 s58, s33, 122880
  s_mov_b32 s35, s48
  s_add_u32 s50, s48, 122880
  s_lshl_b32 s39, s30, 10
  s_add_u32 s39, s39, s48
  s_mul_i32 s43, s32, 491520
  s_mul_i32 s47, s29, 640
  s_add_u32 s43, s43, s47
  s_lshl_b32 s47, s31, 5
  s_add_u32 s37, s37, s47
  s_mul_i32 s37, s37, 196608
  s_mov_b32 s56, s37
  s_add_u32 s78, s37, 24576
  s_add_u32 s37, s37, 36864
  s_mov_b32 s42, 0x3dd53b95
  s_lshl_b32 s46, s31, 4
  s_add_u32 s46, s46, s32
  s_mul_i32 s46, s46, 144000
  s_lshl_b32 s47, s30, 10
  s_add_u32 s76, s46, s47
  s_add_u32 s76, s76, 24576
  s_lshl_b32 s47, s30, 12
  s_lshl_b32 s40, s30, 11
  s_add_u32 s40, s40, 16384
  s_cmp_eq_u32 s29, 0
  s_cselect_b32 s47, s47, s40
  s_add_u32 s46, s46, s47
  s_lshl_b32 s77, s31, 2
  s_mul_i32 s79, s31, 2304000
  s_add_u32 s79, s79, 143360
  s_mul_i32 s85, s32, 144000
  s_add_u32 s85, s85, s79
  s_lshr_b32 s83, s28, 1
  s_lshl_b32 s83, s83, 7
  s_add_u32 s83, s83, s79
  s_bitcmp1_b32 s32, 1
  s_cselect_b32 s91, 48, 64
  s_cselect_b32 s92, 256, 0
  s_and_b32 s47, s32, 1
  s_lshl_b32 s47, s47, 1
  s_and_b32 s40, s28, 1
  s_add_u32 s47, s47, s40
  s_mul_i32 s47, s47, s91
  s_add_u32 s92, s92, s47
  s_lshr_b32 s47, s32, 2
  s_mul_i32 s47, s47, 448
  s_add_u32 s92, s92, s47
  s_lshl_b32 s88, s92, 4
  s_mul_i32 s47, s31, 2304000
  s_add_u32 s88, s88, s47
  s_lshr_b32 s47, s28, 1
  s_mul_i32 s47, s47, 28672
  s_add_u32 s89, s88, s47
  s_mov_b32 s90, 144000
  s_mul_i32 s82, s32, 3
  s_lshr_b32 s82, s82, 2
  s_cmp_eq_u32 s28, 0
  s_cselect_b32 s82, s82, 99
  s_memrealtime s[80:81]
  s_mul_i32 s51, s32, 491520
  s_and_b32 s47, s31, 15
  s_mul_i32 s47, s47, 30720
  s_add_u32 s51, s51, s47
  s_mov_b32 s57, 0
  v_lshrrev_b32 v23, 4, v0
  v_mul_u32_u24 v23, 3072, v23
  v_bfe_u32 v24, v0, 2, 2
  v_lshl_add_u32 v23, v24, 7, v23
  v_and_b32 v24, 1, v0
  v_lshl_add_u32 v23, v24, 3, v23
  v_bfe_u32 v24, v0, 3, 2
  v_lshlrev_b32 v24, 1, v24
  v_bfe_u32 v25, v0, 1, 1
  v_or_b32 v24, v24, v25
  v_lshl_add_u32 v23, v24, 4, v23
  v_add_u32 v23, s48, v23
  s_mul_i32 s47, s30, 3
  s_add_u32 s47, s47, 0
  s_and_b32 s40, s47, 3
  s_lshl_b32 s40, s40, 5
  v_xor_b32 v224, s40, v23
  s_lshr_b32 s47, s47, 2
  s_lshl_b32 s47, s47, 10
  v_add_u32 v224, s47, v224
  s_mul_i32 s47, s30, 3
  s_add_u32 s47, s47, 1
  s_and_b32 s40, s47, 3
  s_lshl_b32 s40, s40, 5
  v_xor_b32 v225, s40, v23
  s_lshr_b32 s47, s47, 2
  s_lshl_b32 s47, s47, 10
  v_add_u32 v225, s47, v225
  s_mul_i32 s47, s30, 3
  s_add_u32 s47, s47, 2
  s_and_b32 s40, s47, 3
  s_lshl_b32 s40, s40, 5
  v_xor_b32 v226, s40, v23
  s_lshr_b32 s47, s47, 2
  s_lshl_b32 s47, s47, 10
  v_add_u32 v226, s47, v226
  v_and_b32 v23, 15, v0
  v_bfe_u32 v24, v0, 1, 3
  v_lshrrev_b32 v25, 4, v0
  v_xor_b32 v24, v24, v25
  v_lshlrev_b32 v23, 7, v23
  v_lshl_add_u32 v230, v24, 4, v23
  v_bfe_u32 v23, v0, 3, 1
  v_mul_u32_u24 v23, 3072, v23
  v_and_b32 v25, 7, v0
  v_lshl_add_u32 v23, v25, 7, v23
  v_lshl_add_u32 v12, v24, 4, v23
  v_lshrrev_b32 v23, 5, v0
  v_mul_u32_u24 v23, 3072, v23
  v_bfe_u32 v24, v0, 2, 3
  v_lshl_add_u32 v23, v24, 7, v23
  v_and_b32 v24, 1, v0
  v_lshl_add_u32 v23, v24, 3, v23
  v_bfe_u32 v24, v0, 3, 2
  v_lshlrev_b32 v24, 1, v24
  v_bfe_u32 v25, v0, 1, 1
  v_or_b32 v24, v24, v25
  v_lshl_add_u32 v16, v24, 4, v23
  v_add_u32 v14, s35, v12
  v_xor_b32 v15, 64, v14
  v_lshrrev_b32 v23, 5, v0
  v_lshlrev_b32 v23, 8, v23
  v_and_b32 v24, 15, v0
  v_lshl_add_u32 v23, v24, 4, v23
  v_bfe_u32 v24, v0, 4, 1
  v_lshl_add_u32 v23, v24, 3, v23
  s_mul_i32 s47, s29, 6144
  s_add_u32 s47, s47, 73728
  s_mul_i32 s40, s30, 1536
  s_add_u32 s40, s40, s47
  v_add_u32 v235, s40, v23
  v_add_u32 v236, 49152, v235
  s_mul_i32 s40, s30, 24576
  s_add_u32 s40, s40, s47
  v_lshlrev_b32 v23, 4, v0
  v_add_u32 v237, s40, v23
  s_cmp_eq_u32 s30, 0
  s_cselect_b32 s47, 73728, 0
  s_sub_u32 s40, s40, s47
  v_add_u32 v31, s40, v23
  v_mov_b32 v8, 0x3f803f80
  v_mov_b32 v9, 0x3f803f80
  v_mov_b32 v10, 0x3f803f80
  v_mov_b32 v11, 0x3f803f80
  v_lshlrev_b32 v238, 4, v0
  s_add_u32 s47, s33, 73728
  v_add_u32 v238, s47, v238
  s_cmp_eq_u32 s29, 0
  s_cbranch_scc1 L_prio
  s_setprio 1
L_prio:
  v_cmp_le_u32 vcc, 24, v0
  s_mul_i32 s47, s30, 24
  v_add_u32 v112, s47, v0
  v_lshlrev_b32 v112, 7, v112
  v_cndmask_b32 v112, v112, v26, vcc
  s_lshr_b32 s47, s2, 3
  s_mul_i32 s64, s47, 10923
  s_lshr_b32 s64, s64, 16
  s_mul_i32 s64, s64, 6
  s_sub_u32 s64, s47, s64
  s_mul_i32 s65, s64, 12288
  s_add_u32 s65, s65, s56
  v_add_u32 v227, 24576, v224
  v_add_u32 v228, 24576, v225
  v_add_u32 v229, 24576, v226
  v_add_u32 v231, 122880, v230
  v_add_u32 v232, 131072, v230
  s_add_u32 m0, s33, 24576
  s_nop 0
  buffer_load_dwordx4 v1, s[16:19], s36 offen  lds
  s_add_u32 m0, s33, 25472
  s_nop 0
  buffer_load_dwordx4 v1, s[16:19], s36 offen offset:128  lds
  s_add_u32 m0, s33, 26368
  s_nop 0
  buffer_load_dwordx4 v1, s[16:19], s36 offen offset:256  lds
  s_add_u32 s36, s36, 393216
  s_add_u32 m0, s33, 49152
  s_nop 0
  buffer_load_dwordx4 v1, s[16:19], s36 offen  lds
  s_add_u32 m0, s33, 50048
  s_nop 0
  buffer_load_dwordx4 v1, s[16:19], s36 offen offset:128  lds
  s_add_u32 m0, s33, 50944
  s_nop 0
  buffer_load_dwordx4 v1, s[16:19], s36 offen offset:256  lds
  s_add_u32 s36, s36, 393216
  s_add_u32 m0, s49, 139264
  s_add_u32 s40, s38, 128
  buffer_load_dwordx4 v5, s[4:7], s40 offen  lds
  s_add_u32 m0, s49, 147456
  s_add_u32 s40, s38, 128
  buffer_load_dwordx4 v6, s[4:7], s40 offen  lds
  s_waitcnt vmcnt(5) lgkmcnt(0)
  s_barrier
  ds_read_b64_tr_b16 v[32:33], v227
  ds_read_b64_tr_b16 v[34:35], v227 offset:512
  ds_read_b64_tr_b16 v[36:37], v228
  ds_read_b64_tr_b16 v[38:39], v228 offset:512
  ds_read_b64_tr_b16 v[40:41], v229
  ds_read_b64_tr_b16 v[42:43], v229 offset:512
  ds_read_b128 v[56:59], v231 offset:0
  ds_read_b128 v[60:63], v231 offset:2048
  ds_read_b128 v[64:67], v231 offset:4096
  ds_read_b128 v[68:71], v231 offset:6144
  ds_read_b128 v[72:75], v232 offset:0
  ds_read_b128 v[76:79], v232 offset:2048
  ds_read_b128 v[80:83], v232 offset:4096
  s_add_u32 m0, s33, 73728
  s_nop 0
  buffer_load_dwordx4 v1, s[16:19], s36 offen  lds
  s_add_u32 m0, s33, 74624
  s_nop 0
  buffer_load_dwordx4 v1, s[16:19], s36 offen offset:128  lds
  s_add_u32 m0, s33, 75520
  s_nop 0
  buffer_load_dwordx4 v1, s[16:19], s36 offen offset:256  lds
  s_add_u32 s36, s36, 393216
  v_add_u32 v227, 49152, v224
  v_add_u32 v228, 49152, v225
  v_add_u32 v229, 49152, v226
  v_xor_b32 v231, 64, v231
  v_xor_b32 v232, 64, v232
  s_waitcnt vmcnt(5) lgkmcnt(0)
  s_barrier
  v_mfma_f32_16x16x32_bf16 v[128:131], v[32:35], v[56:59], 0
  ds_read_b64_tr_b16 v[44:45], v227
  v_mfma_f32_16x16x32_bf16 v[156:159], v[36:39], v[56:59], 0
  ds_read_b64_tr_b16 v[46:47], v227 offset:512
  s_add_u32 m0, s33, 98304
  s_nop 0
  buffer_load_dwordx4 v1, s[16:19], s36 offen  lds
  v_mfma_f32_16x16x32_bf16 v[184:187], v[40:43], v[56:59], 0
  ds_read_b64_tr_b16 v[48:49], v228
  v_mfma_f32_16x16x32_bf16 v[132:135], v[32:35], v[60:63], 0
  ds_read_b64_tr_b16 v[50:51], v228 offset:512
  s_add_u32 m0, s33, 99200
  s_nop 0
  buffer_load_dwordx4 v1, s[16:19], s36 offen offset:128  lds
  v_mfma_f32_16x16x32_bf16 v[160:163], v[36:39], v[60:63], 0
  ds_read_b64_tr_b16 v[52:53], v229
  v_mfma_f32_16x16x32_bf16 v[188:191], v[40:43], v[60:63], 0
  ds_read_b64_tr_b16 v[54:55], v229 offset:512
  s_add_u32 m0, s33, 100096
  s_nop 0
  buffer_load_dwordx4 v1, s[16:19], s36 offen offset:256  lds
  s_add_u32 s36, s36, 393216
  v_mfma_f32_16x16x32_bf16 v[136:139], v[32:35], v[64:67], 0
  ds_read_b128 v[84:87], v231 offset:0
  v_mfma_f32_16x16x32_bf16 v[164:167], v[36:39], v[64:67], 0
  ds_read_b128 v[88:91], v231 offset:2048
  s_add_u32 m0, s49, 155648
  s_add_u32 s40, s38, 256
  buffer_load_dwordx4 v5, s[4:7], s40 offen  lds
  v_mfma_f32_16x16x32_bf16 v[192:195], v[40:43], v[64:67], 0
  ds_read_b128 v[92:95], v231 offset:4096
  v_mfma_f32_16x16x32_bf16 v[140:143], v[32:35], v[68:71], 0
  ds_read_b128 v[96:99], v231 offset:6144
  s_add_u32 m0, s49, 0
  s_add_u32 s40, s38, 256
  buffer_load_dwordx4 v6, s[4:7], s40 offen  lds
  v_mfma_f32_16x16x32_bf16 v[168:171], v[36:39], v[68:71], 0
  ds_read_b128 v[100:103], v232 offset:0
  v_mfma_f32_16x16x32_bf16 v[196:199], v[40:43], v[68:71], 0
  ds_read_b128 v[104:107], v232 offset:2048
  s_add_u32 m0, s33, 24576
  s_nop 0
  buffer_load_dwordx4 v1, s[16:19], s36 offen  lds
  v_mfma_f32_16x16x32_bf16 v[144:147], v[32:35], v[72:75], 0
  ds_read_b128 v[108:111], v232 offset:4096
  v_mfma_f32_16x16x32_bf16 v[172:175], v[36:39], v[72:75], 0
  s_add_u32 m0, s33, 25472
  s_nop 0
  buffer_load_dwordx4 v1, s[16:19], s36 offen offset:128  lds
  v_mfma_f32_16x16x32_bf16 v[200:203], v[40:43], v[72:75], 0
  v_mfma_f32_16x16x32_bf16 v[148:151], v[32:35], v[76:79], 0
  s_add_u32 m0, s33, 26368
  s_nop 0
  buffer_load_dwordx4 v1, s[16:19], s36 offen offset:256  lds
  s_add_u32 s36, s36, 393216
  v_mfma_f32_16x16x32_bf16 v[176:179], v[36:39], v[76:79], 0
  v_mfma_f32_16x16x32_bf16 v[204:207], v[40:43], v[76:79], 0
  v_add_u32 v227, 73728, v224
  v_add_u32 v228, 73728, v225
  v_add_u32 v229, 73728, v226
  v_add_u32 v231, 139264, v230
  v_add_u32 v232, 147456, v230
  v_mfma_f32_16x16x32_bf16 v[152:155], v[32:35], v[80:83], 0
  v_mfma_f32_16x16x32_bf16 v[180:183], v[36:39], v[80:83], 0
  s_or_b32 s47, s32, s28
  s_cmp_lg_u32 s47, 0
  s_cbranch_scc1 L_pub
  s_or_b32 s80, s80, 1
  v_mov_b32 v23, s80
  v_lshlrev_b32 v24, 8, v0
  buffer_store_dword v23, v24, s[72:75], s77 offen sc1
L_pub:
  v_mfma_f32_16x16x32_bf16 v[208:211], v[40:43], v[80:83], 0
  s_waitcnt vmcnt(8) lgkmcnt(0)
  s_barrier
  v_mfma_f32_16x16x32_bf16 v[128:131], v[44:47], v[84:87], v[128:131]
  ds_read_b64_tr_b16 v[32:33], v227
  v_mfma_f32_16x16x32_bf16 v[156:159], v[48:51], v[84:87], v[156:159]
  ds_read_b64_tr_b16 v[34:35], v227 offset:512
  s_add_u32 m0, s33, 49152
  s_nop 0
  buffer_load_dwordx4 v1, s[16:19], s36 offen  lds
  v_mfma_f32_16x16x32_bf16 v[184:187], v[52:55], v[84:87], v[184:187]
  ds_read_b64_tr_b16 v[36:37], v228
  v_mfma_f32_16x16x32_bf16 v[132:135], v[44:47], v[88:91], v[132:135]
  ds_read_b64_tr_b16 v[38:39], v228 offset:512
  s_add_u32 m0, s33, 50048
  s_nop 0
  buffer_load_dwordx4 v1, s[16:19], s36 offen offset:128  lds
  v_mfma_f32_16x16x32_bf16 v[160:163], v[48:51], v[88:91], v[160:163]
  ds_read_b64_tr_b16 v[40:41], v229
  v_mfma_f32_16x16x32_bf16 v[188:191], v[52:55], v[88:91], v[188:191]
  ds_read_b64_tr_b16 v[42:43], v229 offset:512
  s_add_u32 m0, s33, 50944
  s_nop 0
  buffer_load_dwordx4 v1, s[16:19], s36 offen offset:256  lds
  s_add_u32 s36, s36, 393216
  v_mfma_f32_16x16x32_bf16 v[136:139], v[44:47], v[92:95], v[136:139]
  ds_read_b128 v[56:59], v231 offset:0
  v_mfma_f32_16x16x32_bf16 v[164:167], v[48:51], v[92:95], v[164:167]
  ds_read_b128 v[60:63], v231 offset:2048
  s_add_u32 s40, s44, 3932160
  buffer_load_dword v29, v28, s[16:19], s40 offen
  v_mfma_f32_16x16x32_bf16 v[192:195], v[52:55], v[92:95], v[192:195]
  ds_read_b128 v[64:67], v231 offset:4096
  v_mfma_f32_16x16x32_bf16 v[140:143], v[44:47], v[96:99], v[140:143]
  ds_read_b128 v[68:71], v231 offset:6144
  v_mfma_f32_16x16x32_bf16 v[168:171], v[48:51], v[96:99], v[168:171]
  ds_read_b128 v[72:75], v232 offset:0
  v_mfma_f32_16x16x32_bf16 v[196:199], v[52:55], v[96:99], v[196:199]
  ds_read_b128 v[76:79], v232 offset:2048
  v_mfma_f32_16x16x32_bf16 v[144:147], v[44:47], v[100:103], v[144:147]
  ds_read_b128 v[80:83], v232 offset:4096
  v_mfma_f32_16x16x32_bf16 v[172:175], v[48:51], v[100:103], v[172:175]
  v_mfma_f32_16x16x32_bf16 v[200:203], v[52:55], v[100:103], v[200:203]
  v_mfma_f32_16x16x32_bf16 v[148:151], v[44:47], v[104:107], v[148:151]
  v_mfma_f32_16x16x32_bf16 v[176:179], v[48:51], v[104:107], v[176:179]
  v_mfma_f32_16x16x32_bf16 v[204:207], v[52:55], v[104:107], v[204:207]
  v_add_u32 v227, 98304, v224
  v_add_u32 v228, 98304, v225
  v_add_u32 v229, 98304, v226
  v_xor_b32 v231, 64, v231
  v_xor_b32 v232, 64, v232
  v_mfma_f32_16x16x32_bf16 v[152:155], v[44:47], v[108:111], v[152:155]
  v_mfma_f32_16x16x32_bf16 v[180:183], v[48:51], v[108:111], v[180:183]
  v_mfma_f32_16x16x32_bf16 v[208:211], v[52:55], v[108:111], v[208:211]
  s_waitcnt vmcnt(9) lgkmcnt(0)
  s_barrier
  v_mfma_f32_16x16x32_bf16 v[128:131], v[32:35], v[56:59], v[128:131]
  ds_read_b64_tr_b16 v[44:45], v227
  v_mfma_f32_16x16x32_bf16 v[156:159], v[36:39], v[56:59], v[156:159]
  ds_read_b64_tr_b16 v[46:47], v227 offset:512
  s_add_u32 m0, s33, 73728
  s_nop 0
  buffer_load_dwordx4 v1, s[16:19], s36 offen  lds
  v_mfma_f32_16x16x32_bf16 v[184:187], v[40:43], v[56:59], v[184:187]
  ds_read_b64_tr_b16 v[48:49], v228
  v_mfma_f32_16x16x32_bf16 v[132:135], v[32:35], v[60:63], v[132:135]
  ds_read_b64_tr_b16 v[50:51], v228 offset:512
  s_add_u32 m0, s33, 74624
  s_nop 0
  buffer_load_dwordx4 v1, s[16:19], s36 offen offset:128  lds
  v_mfma_f32_16x16x32_bf16 v[160:163], v[36:39], v[60:63], v[160:163]
  ds_read_b64_tr_b16 v[52:53], v229
  v_mfma_f32_16x16x32_bf16 v[188:191], v[40:43], v[60:63], v[188:191]
  ds_read_b64_tr_b16 v[54:55], v229 offset:512
  s_add_u32 m0, s33, 75520
  s_nop 0
  buffer_load_dwordx4 v1, s[16:19], s36 offen offset:256  lds
  s_add_u32 s36, s36, 393216
  v_mfma_f32_16x16x32_bf16 v[136:139], v[32:35], v[64:67], v[136:139]
  ds_read_b128 v[84:87], v231 offset:0
  v_mfma_f32_16x16x32_bf16 v[164:167], v[36:39], v[64:67], v[164:167]
  ds_read_b128 v[88:91], v231 offset:2048
  s_add_u32 m0, s49, 8192
  s_add_u32 s40, s38, 384
  buffer_load_dwordx4 v5, s[4:7], s40 offen  lds
  v_mfma_f32_16x16x32_bf16 v[192:195], v[40:43], v[64:67], v[192:195]
  ds_read_b128 v[92:95], v231 offset:4096
  v_mfma_f32_16x16x32_bf16 v[140:143], v[32:35], v[68:71], v[140:143]
  ds_read_b128 v[96:99], v231 offset:6144
  s_add_u32 m0, s49, 16384
  s_add_u32 s40, s38, 384
  buffer_load_dwordx4 v6, s[4:7], s40 offen  lds
  v_mfma_f32_16x16x32_bf16 v[168:171], v[36:39], v[68:71], v[168:171]
  ds_read_b128 v[100:103], v232 offset:0
  v_mfma_f32_16x16x32_bf16 v[196:199], v[40:43], v[68:71], v[196:199]
  ds_read_b128 v[104:107], v232 offset:2048
  v_mfma_f32_16x16x32_bf16 v[144:147], v[32:35], v[72:75], v[144:147]
  ds_read_b128 v[108:111], v232 offset:4096
  v_mfma_f32_16x16x32_bf16 v[172:175], v[36:39], v[72:75], v[172:175]
  v_mfma_f32_16x16x32_bf16 v[200:203], v[40:43], v[72:75], v[200:203]
  v_mfma_f32_16x16x32_bf16 v[148:151], v[32:35], v[76:79], v[148:151]
  v_mfma_f32_16x16x32_bf16 v[176:179], v[36:39], v[76:79], v[176:179]
  v_mfma_f32_16x16x32_bf16 v[204:207], v[40:43], v[76:79], v[204:207]
  v_add_u32 v227, 24576, v224
  v_add_u32 v228, 24576, v225
  v_add_u32 v229, 24576, v226
  v_add_u32 v231, 155648, v230
  v_add_u32 v232, 0, v230
  v_mfma_f32_16x16x32_bf16 v[152:155], v[32:35], v[80:83], v[152:155]
  v_mfma_f32_16x16x32_bf16 v[180:183], v[36:39], v[80:83], v[180:183]
  v_mfma_f32_16x16x32_bf16 v[208:211], v[40:43], v[80:83], v[208:211]
  s_waitcnt vmcnt(9) lgkmcnt(0)
  s_barrier
  v_mfma_f32_16x16x32_bf16 v[128:131], v[44:47], v[84:87], v[128:131]
  ds_read_b64_tr_b16 v[32:33], v227
  v_mfma_f32_16x16x32_bf16 v[156:159], v[48:51], v[84:87], v[156:159]
  ds_read_b64_tr_b16 v[34:35], v227 offset:512
  v_mfma_f32_16x16x32_bf16 v[184:187], v[52:55], v[84:87], v[184:187]
  ds_read_b64_tr_b16 v[36:37], v228
  v_mfma_f32_16x16x32_bf16 v[132:135], v[44:47], v[88:91], v[132:135]
  ds_read_b64_tr_b16 v[38:39], v228 offset:512
  v_mfma_f32_16x16x32_bf16 v[160:163], v[48:51], v[88:91], v[160:163]
  ds_read_b64_tr_b16 v[40:41], v229
  v_mfma_f32_16x16x32_bf16 v[188:191], v[52:55], v[88:91], v[188:191]
  ds_read_b64_tr_b16 v[42:43], v229 offset:512
  v_mfma_f32_16x16x32_bf16 v[136:139], v[44:47], v[92:95], v[136:139]
  ds_read_b128 v[56:59], v231 offset:0
  v_mfma_f32_16x16x32_bf16 v[164:167], v[48:51], v[92:95], v[164:167]
  ds_read_b128 v[60:63], v231 offset:2048
  v_mfma_f32_16x16x32_bf16 v[192:195], v[52:55], v[92:95], v[192:195]
  ds_read_b128 v[64:67], v231 offset:4096
  v_mfma_f32_16x16x32_bf16 v[140:143], v[44:47], v[96:99], v[140:143]
  ds_read_b128 v[68:71], v231 offset:6144
  v_mfma_f32_16x16x32_bf16 v[168:171], v[48:51], v[96:99], v[168:171]
  ds_read_b128 v[72:75], v232 offset:0
  v_mfma_f32_16x16x32_bf16 v[196:199], v[52:55], v[96:99], v[196:199]
  ds_read_b128 v[76:79], v232 offset:2048
  v_mfma_f32_16x16x32_bf16 v[144:147], v[44:47], v[100:103], v[144:147]
  ds_read_b128 v[80:83], v232 offset:4096
  v_mfma_f32_16x16x32_bf16 v[172:175], v[48:51], v[100:103], v[172:175]
  s_add_u32 m0, s33, 98304
  s_nop 0
  buffer_load_dwordx4 v1, s[16:19], s36 offen  lds
  v_mfma_f32_16x16x32_bf16 v[200:203], v[52:55], v[100:103], v[200:203]
  v_mfma_f32_16x16x32_bf16 v[148:151], v[44:47], v[104:107], v[148:151]
  s_add_u32 m0, s33, 99200
  s_nop 0
  buffer_load_dwordx4 v1, s[16:19], s36 offen offset:128  lds
  v_mfma_f32_16x16x32_bf16 v[176:179], v[48:51], v[104:107], v[176:179]
  v_mfma_f32_16x16x32_bf16 v[204:207], v[52:55], v[104:107], v[204:207]
  s_add_u32 m0, s33, 100096
  s_nop 0
  buffer_load_dwordx4 v1, s[16:19], s36 offen offset:256  lds
  s_add_u32 s36, s36, 393216
  v_add_u32 v227, 49152, v224
  v_add_u32 v228, 49152, v225
  v_add_u32 v229, 49152, v226
  v_xor_b32 v231, 64, v231
  v_xor_b32 v232, 64, v232
  v_mfma_f32_16x16x32_bf16 v[152:155], v[44:47], v[108:111], v[152:155]
  v_mfma_f32_16x16x32_bf16 v[180:183], v[48:51], v[108:111], v[180:183]
  v_mfma_f32_16x16x32_bf16 v[208:211], v[52:55], v[108:111], v[208:211]
  s_waitcnt vmcnt(9) lgkmcnt(0)
  s_barrier
  v_mfma_f32_16x16x32_bf16 v[128:131], v[32:35], v[56:59], v[128:131]
  ds_read_b64_tr_b16 v[44:45], v227
  v_mfma_f32_16x16x32_bf16 v[156:159], v[36:39], v[56:59], v[156:159]
  ds_read_b64_tr_b16 v[46:47], v227 offset:512
  s_add_u32 m0, s33, 24576
  s_nop 0
  buffer_load_dwordx4 v1, s[16:19], s36 offen  lds
  v_mfma_f32_16x16x32_bf16 v[184:187], v[40:43], v[56:59], v[184:187]
  ds_read_b64_tr_b16 v[48:49], v228
  v_mfma_f32_16x16x32_bf16 v[132:135], v[32:35], v[60:63], v[132:135]
  ds_read_b64_tr_b16 v[50:51], v228 offset:512
  s_add_u32 m0, s33, 25472
  s_nop 0
  buffer_load_dwordx4 v1, s[16:19], s36 offen offset:128  lds
  v_mfma_f32_16x16x32_bf16 v[160:163], v[36:39], v[60:63], v[160:163]
  ds_read_b64_tr_b16 v[52:53], v229
  v_mfma_f32_16x16x32_bf16 v[188:191], v[40:43], v[60:63], v[188:191]
  ds_read_b64_tr_b16 v[54:55], v229 offset:512
  s_add_u32 m0, s33, 26368
  s_nop 0
  buffer_load_dwordx4 v1, s[16:19], s36 offen offset:256  lds
  s_add_u32 s36, s36, 393216
  v_mfma_f32_16x16x32_bf16 v[136:139], v[32:35], v[64:67], v[136:139]
  ds_read_b128 v[84:87], v231 offset:0
  v_mfma_f32_16x16x32_bf16 v[164:167], v[36:39], v[64:67], v[164:167]
  ds_read_b128 v[88:91], v231 offset:2048
  s_add_u32 m0, s49, 122880
  s_add_u32 s40, s38, 512
  buffer_load_dwordx4 v5, s[4:7], s40 offen  lds
  v_mfma_f32_16x16x32_bf16 v[192:195], v[40:43], v[64:67], v[192:195]
  ds_read_b128 v[92:95], v231 offset:4096
  v_mfma_f32_16x16x32_bf16 v[140:143], v[32:35], v[68:71], v[140:143]
  ds_read_b128 v[96:99], v231 offset:6144
  s_add_u32 m0, s49, 131072
  s_add_u32 s40, s38, 512
  buffer_load_dwordx4 v6, s[4:7], s40 offen  lds
  v_mfma_f32_16x16x32_bf16 v[168:171], v[36:39], v[68:71], v[168:171]
  ds_read_b128 v[100:103], v232 offset:0
  v_mfma_f32_16x16x32_bf16 v[196:199], v[40:43], v[68:71], v[196:199]
  ds_read_b128 v[104:107], v232 offset:2048
  s_add_u32 m0, s49, 139264
  s_add_u32 s40, s38, 640
  buffer_load_dwordx4 v5, s[4:7], s40 offen  lds
  v_mfma_f32_16x16x32_bf16 v[144:147], v[32:35], v[72:75], v[144:147]
  ds_read_b128 v[108:111], v232 offset:4096
  v_mfma_f32_16x16x32_bf16 v[172:175], v[36:39], v[72:75], v[172:175]
  s_add_u32 m0, s49, 147456
  s_add_u32 s40, s38, 640
  buffer_load_dwordx4 v6, s[4:7], s40 offen  lds
  v_mfma_f32_16x16x32_bf16 v[200:203], v[40:43], v[72:75], v[200:203]
  v_mfma_f32_16x16x32_bf16 v[148:151], v[32:35], v[76:79], v[148:151]
  s_add_u32 s40, s65, 49152
  buffer_load_dword v29, v112, s[8:11], s40 offen
  v_mfma_f32_16x16x32_bf16 v[176:179], v[36:39], v[76:79], v[176:179]
  v_mfma_f32_16x16x32_bf16 v[204:207], v[40:43], v[76:79], v[204:207]
  v_add_u32 v227, 73728, v224
  v_add_u32 v228, 73728, v225
  v_add_u32 v229, 73728, v226
  v_add_u32 v231, 8192, v230
  v_add_u32 v232, 16384, v230
  v_mfma_f32_16x16x32_bf16 v[152:155], v[32:35], v[80:83], v[152:155]
  v_mfma_f32_16x16x32_bf16 v[180:183], v[36:39], v[80:83], v[180:183]
  v_mfma_f32_16x16x32_bf16 v[208:211], v[40:43], v[80:83], v[208:211]
  s_waitcnt vmcnt(11) lgkmcnt(0)
  s_barrier
  v_mfma_f32_16x16x32_bf16 v[128:131], v[44:47], v[84:87], v[128:131]
  ds_read_b64_tr_b16 v[32:33], v227
  v_mfma_f32_16x16x32_bf16 v[156:159], v[48:51], v[84:87], v[156:159]
  ds_read_b64_tr_b16 v[34:35], v227 offset:512
  v_mfma_f32_16x16x32_bf16 v[184:187], v[52:55], v[84:87], v[184:187]
  ds_read_b64_tr_b16 v[36:37], v228
  v_mfma_f32_16x16x32_bf16 v[132:135], v[44:47], v[88:91], v[132:135]
  ds_read_b64_tr_b16 v[38:39], v228 offset:512
  v_mfma_f32_16x16x32_bf16 v[160:163], v[48:51], v[88:91], v[160:163]
  ds_read_b64_tr_b16 v[40:41], v229
  v_mfma_f32_16x16x32_bf16 v[188:191], v[52:55], v[88:91], v[188:191]
  ds_read_b64_tr_b16 v[42:43], v229 offset:512
  v_mfma_f32_16x16x32_bf16 v[136:139], v[44:47], v[92:95], v[136:139]
  ds_read_b128 v[56:59], v231 offset:0
  v_mfma_f32_16x16x32_bf16 v[164:167], v[48:51], v[92:95], v[164:167]
  ds_read_b128 v[60:63], v231 offset:2048
  v_mfma_f32_16x16x32_bf16 v[192:195], v[52:55], v[92:95], v[192:195]
  ds_read_b128 v[64:67], v231 offset:4096
  v_mfma_f32_16x16x32_bf16 v[140:143], v[44:47], v[96:99], v[140:143]
  ds_read_b128 v[68:71], v231 offset:6144
  v_mfma_f32_16x16x32_bf16 v[168:171], v[48:51], v[96:99], v[168:171]
  ds_read_b128 v[72:75], v232 offset:0
  v_mfma_f32_16x16x32_bf16 v[196:199], v[52:55], v[96:99], v[196:199]
  ds_read_b128 v[76:79], v232 offset:2048
  v_mfma_f32_16x16x32_bf16 v[144:147], v[44:47], v[100:103], v[144:147]
  ds_read_b128 v[80:83], v232 offset:4096
  v_mfma_f32_16x16x32_bf16 v[172:175], v[48:51], v[100:103], v[172:175]
  v_mfma_f32_16x16x32_bf16 v[200:203], v[52:55], v[100:103], v[200:203]
  v_mfma_f32_16x16x32_bf16 v[148:151], v[44:47], v[104:107], v[148:151]
  v_mfma_f32_16x16x32_bf16 v[176:179], v[48:51], v[104:107], v[176:179]
  v_mfma_f32_16x16x32_bf16 v[204:207], v[52:55], v[104:107], v[204:207]
  v_add_u32 v227, 98304, v224
  v_add_u32 v228, 98304, v225
  v_add_u32 v229, 98304, v226
  v_xor_b32 v231, 64, v231
  v_xor_b32 v232, 64, v232
  v_mfma_f32_16x16x32_bf16 v[152:155], v[44:47], v[108:111], v[152:155]
  v_mfma_f32_16x16x32_bf16 v[180:183], v[48:51], v[108:111], v[180:183]
  v_mfma_f32_16x16x32_bf16 v[208:211], v[52:55], v[108:111], v[208:211]
  s_waitcnt vmcnt(8) lgkmcnt(0)
  s_barrier
  v_mfma_f32_16x16x32_bf16 v[128:131], v[32:35], v[56:59], v[128:131]
  ds_read_b64_tr_b16 v[44:45], v227
  v_mfma_f32_16x16x32_bf16 v[156:159], v[36:39], v[56:59], v[156:159]
  ds_read_b64_tr_b16 v[46:47], v227 offset:512
  v_mfma_f32_16x16x32_bf16 v[184:187], v[40:43], v[56:59], v[184:187]
  ds_read_b64_tr_b16 v[48:49], v228
  v_mfma_f32_16x16x32_bf16 v[132:135], v[32:35], v[60:63], v[132:135]
  ds_read_b64_tr_b16 v[50:51], v228 offset:512
  v_mfma_f32_16x16x32_bf16 v[160:163], v[36:39], v[60:63], v[160:163]
  ds_read_b64_tr_b16 v[52:53], v229
  v_mfma_f32_16x16x32_bf16 v[188:191], v[40:43], v[60:63], v[188:191]
  ds_read_b64_tr_b16 v[54:55], v229 offset:512
  v_mfma_f32_16x16x32_bf16 v[136:139], v[32:35], v[64:67], v[136:139]
  ds_read_b128 v[84:87], v231 offset:0
  v_mfma_f32_16x16x32_bf16 v[164:167], v[36:39], v[64:67], v[164:167]
  ds_read_b128 v[88:91], v231 offset:2048
  v_mfma_f32_16x16x32_bf16 v[192:195], v[40:43], v[64:67], v[192:195]
  ds_read_b128 v[92:95], v231 offset:4096
  v_mfma_f32_16x16x32_bf16 v[140:143], v[32:35], v[68:71], v[140:143]
  ds_read_b128 v[96:99], v231 offset:6144
  v_mfma_f32_16x16x32_bf16 v[168:171], v[36:39], v[68:71], v[168:171]
  ds_read_b128 v[100:103], v232 offset:0
  v_mfma_f32_16x16x32_bf16 v[196:199], v[40:43], v[68:71], v[196:199]
  ds_read_b128 v[104:107], v232 offset:2048
  v_mfma_f32_16x16x32_bf16 v[144:147], v[32:35], v[72:75], v[144:147]
  ds_read_b128 v[108:111], v232 offset:4096
  v_mfma_f32_16x16x32_bf16 v[172:175], v[36:39], v[72:75], v[172:175]
  v_mfma_f32_16x16x32_bf16 v[200:203], v[40:43], v[72:75], v[200:203]
  v_mfma_f32_16x16x32_bf16 v[148:151], v[32:35], v[76:79], v[148:151]
  s_add_u32 m0, s33, 49152
  s_nop 0
  buffer_load_dwordx4 v1, s[16:19], s36 offen  lds
  v_mfma_f32_16x16x32_bf16 v[176:179], v[36:39], v[76:79], v[176:179]
  s_add_u32 m0, s33, 50048
  s_nop 0
  buffer_load_dwordx4 v1, s[16:19], s36 offen offset:128  lds
  v_mfma_f32_16x16x32_bf16 v[204:207], v[40:43], v[76:79], v[204:207]
  s_add_u32 m0, s33, 50944
  s_nop 0
  buffer_load_dwordx4 v1, s[16:19], s36 offen offset:256  lds
  s_add_u32 s36, s36, 393216
  v_add_u32 v227, 24576, v224
  v_add_u32 v228, 24576, v225
  v_add_u32 v229, 24576, v226
  v_add_u32 v231, 122880, v230
  v_add_u32 v232, 131072, v230
  v_mfma_f32_16x16x32_bf16 v[152:155], v[32:35], v[80:83], v[152:155]
  s_add_u32 m0, s33, 73728
  s_nop 0
  buffer_load_dwordx4 v1, s[16:19], s36 offen  lds
  v_mfma_f32_16x16x32_bf16 v[180:183], v[36:39], v[80:83], v[180:183]
  s_add_u32 m0, s33, 74624
  s_nop 0
  buffer_load_dwordx4 v1, s[16:19], s36 offen offset:128  lds
  v_mfma_f32_16x16x32_bf16 v[208:211], v[40:43], v[80:83], v[208:211]
  s_add_u32 m0, s33, 75520
  s_nop 0
  buffer_load_dwordx4 v1, s[16:19], s36 offen offset:256  lds
  s_add_u32 s36, s36, 393216
  s_waitcnt vmcnt(9) lgkmcnt(0)
  s_barrier
  v_mfma_f32_16x16x32_bf16 v[128:131], v[44:47], v[84:87], v[128:131]
  ds_read_b64_tr_b16 v[32:33], v227
  v_mfma_f32_16x16x32_bf16 v[156:159], v[48:51], v[84:87], v[156:159]
  ds_read_b64_tr_b16 v[34:35], v227 offset:512
  v_mfma_f32_16x16x32_bf16 v[184:187], v[52:55], v[84:87], v[184:187]
  ds_read_b64_tr_b16 v[36:37], v228
  v_mfma_f32_16x16x32_bf16 v[132:135], v[44:47], v[88:91], v[132:135]
  ds_read_b64_tr_b16 v[38:39], v228 offset:512
  v_mfma_f32_16x16x32_bf16 v[160:163], v[48:51], v[88:91], v[160:163]
  ds_read_b64_tr_b16 v[40:41], v229
  v_mfma_f32_16x16x32_bf16 v[188:191], v[52:55], v[88:91], v[188:191]
  ds_read_b64_tr_b16 v[42:43], v229 offset:512
  v_mfma_f32_16x16x32_bf16 v[136:139], v[44:47], v[92:95], v[136:139]
  ds_read_b128 v[56:59], v231 offset:0
  v_mfma_f32_16x16x32_bf16 v[164:167], v[48:51], v[92:95], v[164:167]
  ds_read_b128 v[60:63], v231 offset:2048
  v_mfma_f32_16x16x32_bf16 v[192:195], v[52:55], v[92:95], v[192:195]
  ds_read_b128 v[64:67], v231 offset:4096
  v_mfma_f32_16x16x32_bf16 v[140:143], v[44:47], v[96:99], v[140:143]
  ds_read_b128 v[68:71], v231 offset:6144
  v_mfma_f32_16x16x32_bf16 v[168:171], v[48:51], v[96:99], v[168:171]
  ds_read_b128 v[72:75], v232 offset:0
  v_mfma_f32_16x16x32_bf16 v[196:199], v[52:55], v[96:99], v[196:199]
  ds_read_b128 v[76:79], v232 offset:2048
  v_mfma_f32_16x16x32_bf16 v[144:147], v[44:47], v[100:103], v[144:147]
  ds_read_b128 v[80:83], v232 offset:4096
  v_mfma_f32_16x16x32_bf16 v[172:175], v[48:51], v[100:103], v[172:175]
  s_add_u32 m0, s33, 98304
  s_nop 0
  buffer_load_dwordx4 v1, s[16:19], s36 offen  lds
  v_mfma_f32_16x16x32_bf16 v[200:203], v[52:55], v[100:103], v[200:203]
  v_mfma_f32_16x16x32_bf16 v[148:151], v[44:47], v[104:107], v[148:151]
  s_add_u32 m0, s33, 99200
  s_nop 0
  buffer_load_dwordx4 v1, s[16:19], s36 offen offset:128  lds
  v_mfma_f32_16x16x32_bf16 v[176:179], v[48:51], v[104:107], v[176:179]
  v_mfma_f32_16x16x32_bf16 v[204:207], v[52:55], v[104:107], v[204:207]
  s_add_u32 m0, s33, 100096
  s_nop 0
  buffer_load_dwordx4 v1, s[16:19], s36 offen offset:256  lds
  s_add_u32 s36, s36, 393216
  v_add_u32 v227, 49152, v224
  v_add_u32 v228, 49152, v225
  v_add_u32 v229, 49152, v226
  v_xor_b32 v231, 64, v231
  v_xor_b32 v232, 64, v232
  v_mfma_f32_16x16x32_bf16 v[152:155], v[44:47], v[108:111], v[152:155]
  v_mfma_f32_16x16x32_bf16 v[180:183], v[48:51], v[108:111], v[180:183]
  v_mfma_f32_16x16x32_bf16 v[208:211], v[52:55], v[108:111], v[208:211]
  s_waitcnt vmcnt(6) lgkmcnt(0)
  s_barrier
  v_mfma_f32_16x16x32_bf16 v[128:131], v[32:35], v[56:59], v[128:131]
  ds_read_b64_tr_b16 v[44:45], v227
  v_mfma_f32_16x16x32_bf16 v[156:159], v[36:39], v[56:59], v[156:159]
  ds_read_b64_tr_b16 v[46:47], v227 offset:512
  s_add_u32 m0, s33, 24576
  s_nop 0
  buffer_load_dwordx4 v1, s[16:19], s36 offen  lds
  v_mfma_f32_16x16x32_bf16 v[184:187], v[40:43], v[56:59], v[184:187]
  ds_read_b64_tr_b16 v[48:49], v228
  v_mfma_f32_16x16x32_bf16 v[132:135], v[32:35], v[60:63], v[132:135]
  ds_read_b64_tr_b16 v[50:51], v228 offset:512
  s_add_u32 m0, s33, 25472
  s_nop 0
  buffer_load_dwordx4 v1, s[16:19], s36 offen offset:128  lds
  v_mfma_f32_16x16x32_bf16 v[160:163], v[36:39], v[60:63], v[160:163]
  ds_read_b64_tr_b16 v[52:53], v229
  v_mfma_f32_16x16x32_bf16 v[188:191], v[40:43], v[60:63], v[188:191]
  ds_read_b64_tr_b16 v[54:55], v229 offset:512
  s_add_u32 m0, s33, 26368
  s_nop 0
  buffer_load_dwordx4 v1, s[16:19], s36 offen offset:256  lds
  s_add_u32 s36, s36, 393216
  v_mfma_f32_16x16x32_bf16 v[136:139], v[32:35], v[64:67], v[136:139]
  ds_read_b128 v[84:87], v231 offset:0
  v_mfma_f32_16x16x32_bf16 v[164:167], v[36:39], v[64:67], v[164:167]
  ds_read_b128 v[88:91], v231 offset:2048
  s_add_u32 m0, s49, 155648
  s_add_u32 s40, s38, 768
  buffer_load_dwordx4 v5, s[4:7], s40 offen  lds
  v_mfma_f32_16x16x32_bf16 v[192:195], v[40:43], v[64:67], v[192:195]
  ds_read_b128 v[92:95], v231 offset:4096
  v_mfma_f32_16x16x32_bf16 v[140:143], v[32:35], v[68:71], v[140:143]
  ds_read_b128 v[96:99], v231 offset:6144
  s_add_u32 m0, s49, 0
  s_add_u32 s40, s38, 768
  buffer_load_dwordx4 v6, s[4:7], s40 offen  lds
  v_mfma_f32_16x16x32_bf16 v[168:171], v[36:39], v[68:71], v[168:171]
  ds_read_b128 v[100:103], v232 offset:0
  v_mfma_f32_16x16x32_bf16 v[196:199], v[40:43], v[68:71], v[196:199]
  ds_read_b128 v[104:107], v232 offset:2048
  s_add_u32 m0, s49, 8192
  s_add_u32 s40, s38, 896
  buffer_load_dwordx4 v5, s[4:7], s40 offen  lds
  v_mfma_f32_16x16x32_bf16 v[144:147], v[32:35], v[72:75], v[144:147]
  ds_read_b128 v[108:111], v232 offset:4096
  v_mfma_f32_16x16x32_bf16 v[172:175], v[36:39], v[72:75], v[172:175]
  s_add_u32 m0, s49, 16384
  s_add_u32 s40, s38, 896
  buffer_load_dwordx4 v6, s[4:7], s40 offen  lds
  v_mfma_f32_16x16x32_bf16 v[200:203], v[40:43], v[72:75], v[200:203]
  v_mfma_f32_16x16x32_bf16 v[148:151], v[32:35], v[76:79], v[148:151]
  s_add_u32 s40, s65, 49152
  buffer_load_dword v29, v112, s[12:15], s40 offen
  v_mfma_f32_16x16x32_bf16 v[176:179], v[36:39], v[76:79], v[176:179]
  v_mfma_f32_16x16x32_bf16 v[204:207], v[40:43], v[76:79], v[204:207]
  v_add_u32 v227, 73728, v224
  v_add_u32 v228, 73728, v225
  v_add_u32 v229, 73728, v226
  v_add_u32 v231, 139264, v230
  v_add_u32 v232, 147456, v230
  v_mfma_f32_16x16x32_bf16 v[152:155], v[32:35], v[80:83], v[152:155]
  v_mfma_f32_16x16x32_bf16 v[180:183], v[36:39], v[80:83], v[180:183]
  v_mfma_f32_16x16x32_bf16 v[208:211], v[40:43], v[80:83], v[208:211]
  s_waitcnt vmcnt(11) lgkmcnt(0)
  s_barrier
  v_mfma_f32_16x16x32_bf16 v[128:131], v[44:47], v[84:87], v[128:131]
  ds_read_b64_tr_b16 v[32:33], v227
  v_mfma_f32_16x16x32_bf16 v[156:159], v[48:51], v[84:87], v[156:159]
  ds_read_b64_tr_b16 v[34:35], v227 offset:512
  v_mfma_f32_16x16x32_bf16 v[184:187], v[52:55], v[84:87], v[184:187]
  ds_read_b64_tr_b16 v[36:37], v228
  v_mfma_f32_16x16x32_bf16 v[132:135], v[44:47], v[88:91], v[132:135]
  ds_read_b64_tr_b16 v[38:39], v228 offset:512
  v_mfma_f32_16x16x32_bf16 v[160:163], v[48:51], v[88:91], v[160:163]
  ds_read_b64_tr_b16 v[40:41], v229
  v_mfma_f32_16x16x32_bf16 v[188:191], v[52:55], v[88:91], v[188:191]
  ds_read_b64_tr_b16 v[42:43], v229 offset:512
  v_mfma_f32_16x16x32_bf16 v[136:139], v[44:47], v[92:95], v[136:139]
  ds_read_b128 v[56:59], v231 offset:0
  v_mfma_f32_16x16x32_bf16 v[164:167], v[48:51], v[92:95], v[164:167]
  ds_read_b128 v[60:63], v231 offset:2048
  v_mfma_f32_16x16x32_bf16 v[192:195], v[52:55], v[92:95], v[192:195]
  ds_read_b128 v[64:67], v231 offset:4096
  v_mfma_f32_16x16x32_bf16 v[140:143], v[44:47], v[96:99], v[140:143]
  ds_read_b128 v[68:71], v231 offset:6144
  v_mfma_f32_16x16x32_bf16 v[168:171], v[48:51], v[96:99], v[168:171]
  ds_read_b128 v[72:75], v232 offset:0
  v_mfma_f32_16x16x32_bf16 v[196:199], v[52:55], v[96:99], v[196:199]
  ds_read_b128 v[76:79], v232 offset:2048
  v_mfma_f32_16x16x32_bf16 v[144:147], v[44:47], v[100:103], v[144:147]
  ds_read_b128 v[80:83], v232 offset:4096
  v_mfma_f32_16x16x32_bf16 v[172:175], v[48:51], v[100:103], v[172:175]
  v_mfma_f32_16x16x32_bf16 v[200:203], v[52:55], v[100:103], v[200:203]
  v_mfma_f32_16x16x32_bf16 v[148:151], v[44:47], v[104:107], v[148:151]
  v_mfma_f32_16x16x32_bf16 v[176:179], v[48:51], v[104:107], v[176:179]
  v_mfma_f32_16x16x32_bf16 v[204:207], v[52:55], v[104:107], v[204:207]
  v_add_u32 v227, 98304, v224
  v_add_u32 v228, 98304, v225
  v_add_u32 v229, 98304, v226
  v_xor_b32 v231, 64, v231
  v_xor_b32 v232, 64, v232
  v_mfma_f32_16x16x32_bf16 v[152:155], v[44:47], v[108:111], v[152:155]
  v_mfma_f32_16x16x32_bf16 v[180:183], v[48:51], v[108:111], v[180:183]
  v_mfma_f32_16x16x32_bf16 v[208:211], v[52:55], v[108:111], v[208:211]
  s_waitcnt vmcnt(8) lgkmcnt(0)
  s_barrier
  v_mfma_f32_16x16x32_bf16 v[128:131], v[32:35], v[56:59], v[128:131]
  ds_read_b64_tr_b16 v[44:45], v227
  v_mfma_f32_16x16x32_bf16 v[156:159], v[36:39], v[56:59], v[156:159]
  ds_read_b64_tr_b16 v[46:47], v227 offset:512
  v_mfma_f32_16x16x32_bf16 v[184:187], v[40:43], v[56:59], v[184:187]
  ds_read_b64_tr_b16 v[48:49], v228
  v_mfma_f32_16x16x32_bf16 v[132:135], v[32:35], v[60:63], v[132:135]
  ds_read_b64_tr_b16 v[50:51], v228 offset:512
  v_mfma_f32_16x16x32_bf16 v[160:163], v[36:39], v[60:63], v[160:163]
  ds_read_b64_tr_b16 v[52:53], v229
  v_mfma_f32_16x16x32_bf16 v[188:191], v[40:43], v[60:63], v[188:191]
  ds_read_b64_tr_b16 v[54:55], v229 offset:512
  v_mfma_f32_16x16x32_bf16 v[136:139], v[32:35], v[64:67], v[136:139]
  ds_read_b128 v[84:87], v231 offset:0
  v_mfma_f32_16x16x32_bf16 v[164:167], v[36:39], v[64:67], v[164:167]
  ds_read_b128 v[88:91], v231 offset:2048
  v_mfma_f32_16x16x32_bf16 v[192:195], v[40:43], v[64:67], v[192:195]
  ds_read_b128 v[92:95], v231 offset:4096
  v_mfma_f32_16x16x32_bf16 v[140:143], v[32:35], v[68:71], v[140:143]
  ds_read_b128 v[96:99], v231 offset:6144
  v_mfma_f32_16x16x32_bf16 v[168:171], v[36:39], v[68:71], v[168:171]
  ds_read_b128 v[100:103], v232 offset:0
  v_mfma_f32_16x16x32_bf16 v[196:199], v[40:43], v[68:71], v[196:199]
  ds_read_b128 v[104:107], v232 offset:2048
  v_mfma_f32_16x16x32_bf16 v[144:147], v[32:35], v[72:75], v[144:147]
  ds_read_b128 v[108:111], v232 offset:4096
  v_mfma_f32_16x16x32_bf16 v[172:175], v[36:39], v[72:75], v[172:175]
  v_mfma_f32_16x16x32_bf16 v[200:203], v[40:43], v[72:75], v[200:203]
  v_mfma_f32_16x16x32_bf16 v[148:151], v[32:35], v[76:79], v[148:151]
  s_add_u32 m0, s33, 49152
  s_nop 0
  buffer_load_dwordx4 v1, s[16:19], s36 offen  lds
  v_mfma_f32_16x16x32_bf16 v[176:179], v[36:39], v[76:79], v[176:179]
  s_add_u32 m0, s33, 50048
  s_nop 0
  buffer_load_dwordx4 v1, s[16:19], s36 offen offset:128  lds
  v_mfma_f32_16x16x32_bf16 v[204:207], v[40:43], v[76:79], v[204:207]
  s_add_u32 m0, s33, 50944
  s_nop 0
  buffer_load_dwordx4 v1, s[16:19], s36 offen offset:256  lds
  s_add_u32 s36, s36, 393216
  v_add_u32 v227, 24576, v224
  v_add_u32 v228, 24576, v225
  v_add_u32 v229, 24576, v226
  v_add_u32 v231, 155648, v230
  v_add_u32 v232, 0, v230
  v_mfma_f32_16x16x32_bf16 v[152:155], v[32:35], v[80:83], v[152:155]
  s_add_u32 m0, s33, 73728
  s_nop 0
  buffer_load_dwordx4 v1, s[16:19], s36 offen  lds
  v_mfma_f32_16x16x32_bf16 v[180:183], v[36:39], v[80:83], v[180:183]
  s_add_u32 m0, s33, 74624
  s_nop 0
  buffer_load_dwordx4 v1, s[16:19], s36 offen offset:128  lds
  v_mfma_f32_16x16x32_bf16 v[208:211], v[40:43], v[80:83], v[208:211]
  s_add_u32 m0, s33, 75520
  s_nop 0
  buffer_load_dwordx4 v1, s[16:19], s36 offen offset:256  lds
  s_add_u32 s36, s36, 393216
  s_waitcnt vmcnt(9) lgkmcnt(0)
  s_barrier
  v_mfma_f32_16x16x32_bf16 v[128:131], v[44:47], v[84:87], v[128:131]
  ds_read_b64_tr_b16 v[32:33], v227
  v_mfma_f32_16x16x32_bf16 v[156:159], v[48:51], v[84:87], v[156:159]
  ds_read_b64_tr_b16 v[34:35], v227 offset:512
  v_mfma_f32_16x16x32_bf16 v[184:187], v[52:55], v[84:87], v[184:187]
  ds_read_b64_tr_b16 v[36:37], v228
  v_mfma_f32_16x16x32_bf16 v[132:135], v[44:47], v[88:91], v[132:135]
  ds_read_b64_tr_b16 v[38:39], v228 offset:512
  v_mfma_f32_16x16x32_bf16 v[160:163], v[48:51], v[88:91], v[160:163]
  ds_read_b64_tr_b16 v[40:41], v229
  v_mfma_f32_16x16x32_bf16 v[188:191], v[52:55], v[88:91], v[188:191]
  ds_read_b64_tr_b16 v[42:43], v229 offset:512
  v_mfma_f32_16x16x32_bf16 v[136:139], v[44:47], v[92:95], v[136:139]
  ds_read_b128 v[56:59], v231 offset:0
  v_mfma_f32_16x16x32_bf16 v[164:167], v[48:51], v[92:95], v[164:167]
  ds_read_b128 v[60:63], v231 offset:2048
  v_mfma_f32_16x16x32_bf16 v[192:195], v[52:55], v[92:95], v[192:195]
  ds_read_b128 v[64:67], v231 offset:4096
  v_mfma_f32_16x16x32_bf16 v[140:143], v[44:47], v[96:99], v[140:143]
  ds_read_b128 v[68:71], v231 offset:6144
  v_mfma_f32_16x16x32_bf16 v[168:171], v[48:51], v[96:99], v[168:171]
  ds_read_b128 v[72:75], v232 offset:0
  v_mfma_f32_16x16x32_bf16 v[196:199], v[52:55], v[96:99], v[196:199]
  ds_read_b128 v[76:79], v232 offset:2048
  v_mfma_f32_16x16x32_bf16 v[144:147], v[44:47], v[100:103], v[144:147]
  ds_read_b128 v[80:83], v232 offset:4096
  v_mfma_f32_16x16x32_bf16 v[172:175], v[48:51], v[100:103], v[172:175]
  s_add_u32 m0, s33, 98304
  s_nop 0
  buffer_load_dwordx4 v1, s[16:19], s36 offen  lds
  v_mfma_f32_16x16x32_bf16 v[200:203], v[52:55], v[100:103], v[200:203]
  v_mfma_f32_16x16x32_bf16 v[148:151], v[44:47], v[104:107], v[148:151]
  s_add_u32 m0, s33, 99200
  s_nop 0
  buffer_load_dwordx4 v1, s[16:19], s36 offen offset:128  lds
  v_mfma_f32_16x16x32_bf16 v[176:179], v[48:51], v[104:107], v[176:179]
  v_mfma_f32_16x16x32_bf16 v[204:207], v[52:55], v[104:107], v[204:207]
  s_add_u32 m0, s33, 100096
  s_nop 0
  buffer_load_dwordx4 v1, s[16:19], s36 offen offset:256  lds
  s_add_u32 s36, s36, 393216
  v_add_u32 v227, 49152, v224
  v_add_u32 v228, 49152, v225
  v_add_u32 v229, 49152, v226
  v_xor_b32 v231, 64, v231
  v_xor_b32 v232, 64, v232
  v_mfma_f32_16x16x32_bf16 v[152:155], v[44:47], v[108:111], v[152:155]
  v_mfma_f32_16x16x32_bf16 v[180:183], v[48:51], v[108:111], v[180:183]
  v_mfma_f32_16x16x32_bf16 v[208:211], v[52:55], v[108:111], v[208:211]
  s_waitcnt vmcnt(6) lgkmcnt(0)
  s_barrier
  v_mfma_f32_16x16x32_bf16 v[128:131], v[32:35], v[56:59], v[128:131]
  ds_read_b64_tr_b16 v[44:45], v227
  v_mfma_f32_16x16x32_bf16 v[156:159], v[36:39], v[56:59], v[156:159]
  ds_read_b64_tr_b16 v[46:47], v227 offset:512
  s_add_u32 m0, s33, 24576
  s_nop 0
  buffer_load_dwordx4 v1, s[16:19], s36 offen  lds
  v_mfma_f32_16x16x32_bf16 v[184:187], v[40:43], v[56:59], v[184:187]
  ds_read_b64_tr_b16 v[48:49], v228
  v_mfma_f32_16x16x32_bf16 v[132:135], v[32:35], v[60:63], v[132:135]
  ds_read_b64_tr_b16 v[50:51], v228 offset:512
  s_add_u32 m0, s33, 25472
  s_nop 0
  buffer_load_dwordx4 v1, s[16:19], s36 offen offset:128  lds
  v_mfma_f32_16x16x32_bf16 v[160:163], v[36:39], v[60:63], v[160:163]
  ds_read_b64_tr_b16 v[52:53], v229
  v_mfma_f32_16x16x32_bf16 v[188:191], v[40:43], v[60:63], v[188:191]
  ds_read_b64_tr_b16 v[54:55], v229 offset:512
  s_add_u32 m0, s33, 26368
  s_nop 0
  buffer_load_dwordx4 v1, s[16:19], s36 offen offset:256  lds
  s_add_u32 s36, s36, 393216
  v_mfma_f32_16x16x32_bf16 v[136:139], v[32:35], v[64:67], v[136:139]
  ds_read_b128 v[84:87], v231 offset:0
  v_mfma_f32_16x16x32_bf16 v[164:167], v[36:39], v[64:67], v[164:167]
  ds_read_b128 v[88:91], v231 offset:2048
  s_add_u32 m0, s49, 122880
  s_add_u32 s40, s38, 1024
  buffer_load_dwordx4 v5, s[4:7], s40 offen  lds
  v_mfma_f32_16x16x32_bf16 v[192:195], v[40:43], v[64:67], v[192:195]
  ds_read_b128 v[92:95], v231 offset:4096
  v_mfma_f32_16x16x32_bf16 v[140:143], v[32:35], v[68:71], v[140:143]
  ds_read_b128 v[96:99], v231 offset:6144
  s_add_u32 m0, s49, 131072
  s_add_u32 s40, s38, 1024
  buffer_load_dwordx4 v6, s[4:7], s40 offen  lds
  v_mfma_f32_16x16x32_bf16 v[168:171], v[36:39], v[68:71], v[168:171]
  ds_read_b128 v[100:103], v232 offset:0
  v_mfma_f32_16x16x32_bf16 v[196:199], v[40:43], v[68:71], v[196:199]
  ds_read_b128 v[104:107], v232 offset:2048
  s_add_u32 m0, s49, 139264
  s_add_u32 s40, s38, 1152
  buffer_load_dwordx4 v5, s[4:7], s40 offen  lds
  v_mfma_f32_16x16x32_bf16 v[144:147], v[32:35], v[72:75], v[144:147]
  ds_read_b128 v[108:111], v232 offset:4096
  v_mfma_f32_16x16x32_bf16 v[172:175], v[36:39], v[72:75], v[172:175]
  s_add_u32 m0, s49, 147456
  s_add_u32 s40, s38, 1152
  buffer_load_dwordx4 v6, s[4:7], s40 offen  lds
  v_mfma_f32_16x16x32_bf16 v[200:203], v[40:43], v[72:75], v[200:203]
  v_mfma_f32_16x16x32_bf16 v[148:151], v[32:35], v[76:79], v[148:151]
  s_add_u32 s40, s65, 122880
  buffer_load_dword v29, v112, s[8:11], s40 offen
  v_mfma_f32_16x16x32_bf16 v[176:179], v[36:39], v[76:79], v[176:179]
  v_mfma_f32_16x16x32_bf16 v[204:207], v[40:43], v[76:79], v[204:207]
  v_add_u32 v227, 73728, v224
  v_add_u32 v228, 73728, v225
  v_add_u32 v229, 73728, v226
  v_add_u32 v231, 8192, v230
  v_add_u32 v232, 16384, v230
  v_mfma_f32_16x16x32_bf16 v[152:155], v[32:35], v[80:83], v[152:155]
  v_mfma_f32_16x16x32_bf16 v[180:183], v[36:39], v[80:83], v[180:183]
  v_mfma_f32_16x16x32_bf16 v[208:211], v[40:43], v[80:83], v[208:211]
  s_waitcnt vmcnt(11) lgkmcnt(0)
  s_barrier
  v_mfma_f32_16x16x32_bf16 v[128:131], v[44:47], v[84:87], v[128:131]
  ds_read_b64_tr_b16 v[32:33], v227
  v_mfma_f32_16x16x32_bf16 v[156:159], v[48:51], v[84:87], v[156:159]
  ds_read_b64_tr_b16 v[34:35], v227 offset:512
  v_mfma_f32_16x16x32_bf16 v[184:187], v[52:55], v[84:87], v[184:187]
  ds_read_b64_tr_b16 v[36:37], v228
  v_mfma_f32_16x16x32_bf16 v[132:135], v[44:47], v[88:91], v[132:135]
  ds_read_b64_tr_b16 v[38:39], v228 offset:512
  v_mfma_f32_16x16x32_bf16 v[160:163], v[48:51], v[88:91], v[160:163]
  ds_read_b64_tr_b16 v[40:41], v229
  v_mfma_f32_16x16x32_bf16 v[188:191], v[52:55], v[88:91], v[188:191]
  ds_read_b64_tr_b16 v[42:43], v229 offset:512
  v_mfma_f32_16x16x32_bf16 v[136:139], v[44:47], v[92:95], v[136:139]
  ds_read_b128 v[56:59], v231 offset:0
  v_mfma_f32_16x16x32_bf16 v[164:167], v[48:51], v[92:95], v[164:167]
  ds_read_b128 v[60:63], v231 offset:2048
  v_mfma_f32_16x16x32_bf16 v[192:195], v[52:55], v[92:95], v[192:195]
  ds_read_b128 v[64:67], v231 offset:4096
  v_mfma_f32_16x16x32_bf16 v[140:143], v[44:47], v[96:99], v[140:143]
  ds_read_b128 v[68:71], v231 offset:6144
  v_mfma_f32_16x16x32_bf16 v[168:171], v[48:51], v[96:99], v[168:171]
  ds_read_b128 v[72:75], v232 offset:0
  v_mfma_f32_16x16x32_bf16 v[196:199], v[52:55], v[96:99], v[196:199]
  ds_read_b128 v[76:79], v232 offset:2048
  v_mfma_f32_16x16x32_bf16 v[144:147], v[44:47], v[100:103], v[144:147]
  ds_read_b128 v[80:83], v232 offset:4096
  v_mfma_f32_16x16x32_bf16 v[172:175], v[48:51], v[100:103], v[172:175]
  v_mfma_f32_16x16x32_bf16 v[200:203], v[52:55], v[100:103], v[200:203]
  v_mfma_f32_16x16x32_bf16 v[148:151], v[44:47], v[104:107], v[148:151]
  v_mfma_f32_16x16x32_bf16 v[176:179], v[48:51], v[104:107], v[176:179]
  v_mfma_f32_16x16x32_bf16 v[204:207], v[52:55], v[104:107], v[204:207]
  v_add_u32 v227, 98304, v224
  v_add_u32 v228, 98304, v225
  v_add_u32 v229, 98304, v226
  v_xor_b32 v231, 64, v231
  v_xor_b32 v232, 64, v232
  v_mfma_f32_16x16x32_bf16 v[152:155], v[44:47], v[108:111], v[152:155]
  v_mfma_f32_16x16x32_bf16 v[180:183], v[48:51], v[108:111], v[180:183]
  v_mfma_f32_16x16x32_bf16 v[208:211], v[52:55], v[108:111], v[208:211]
  s_waitcnt vmcnt(8) lgkmcnt(0)
  s_barrier
  v_mfma_f32_16x16x32_bf16 v[128:131], v[32:35], v[56:59], v[128:131]
  ds_read_b64_tr_b16 v[44:45], v227
  v_mfma_f32_16x16x32_bf16 v[156:159], v[36:39], v[56:59], v[156:159]
  ds_read_b64_tr_b16 v[46:47], v227 offset:512
  v_mfma_f32_16x16x32_bf16 v[184:187], v[40:43], v[56:59], v[184:187]
  ds_read_b64_tr_b16 v[48:49], v228
  v_mfma_f32_16x16x32_bf16 v[132:135], v[32:35], v[60:63], v[132:135]
  ds_read_b64_tr_b16 v[50:51], v228 offset:512
  v_mfma_f32_16x16x32_bf16 v[160:163], v[36:39], v[60:63], v[160:163]
  ds_read_b64_tr_b16 v[52:53], v229
  v_mfma_f32_16x16x32_bf16 v[188:191], v[40:43], v[60:63], v[188:191]
  ds_read_b64_tr_b16 v[54:55], v229 offset:512
  v_mfma_f32_16x16x32_bf16 v[136:139], v[32:35], v[64:67], v[136:139]
  ds_read_b128 v[84:87], v231 offset:0
  v_mfma_f32_16x16x32_bf16 v[164:167], v[36:39], v[64:67], v[164:167]
  ds_read_b128 v[88:91], v231 offset:2048
  v_mfma_f32_16x16x32_bf16 v[192:195], v[40:43], v[64:67], v[192:195]
  ds_read_b128 v[92:95], v231 offset:4096
  v_mfma_f32_16x16x32_bf16 v[140:143], v[32:35], v[68:71], v[140:143]
  ds_read_b128 v[96:99], v231 offset:6144
  v_mfma_f32_16x16x32_bf16 v[168:171], v[36:39], v[68:71], v[168:171]
  ds_read_b128 v[100:103], v232 offset:0
  v_mfma_f32_16x16x32_bf16 v[196:199], v[40:43], v[68:71], v[196:199]
  ds_read_b128 v[104:107], v232 offset:2048
  v_mfma_f32_16x16x32_bf16 v[144:147], v[32:35], v[72:75], v[144:147]
  ds_read_b128 v[108:111], v232 offset:4096
  v_mfma_f32_16x16x32_bf16 v[172:175], v[36:39], v[72:75], v[172:175]
  v_mfma_f32_16x16x32_bf16 v[200:203], v[40:43], v[72:75], v[200:203]
  v_mfma_f32_16x16x32_bf16 v[148:151], v[32:35], v[76:79], v[148:151]
  s_add_u32 m0, s33, 49152
  s_nop 0
  buffer_load_dwordx4 v1, s[16:19], s36 offen  lds
  v_mfma_f32_16x16x32_bf16 v[176:179], v[36:39], v[76:79], v[176:179]
  s_add_u32 m0, s33, 50048
  s_nop 0
  buffer_load_dwordx4 v1, s[16:19], s36 offen offset:128  lds
  v_mfma_f32_16x16x32_bf16 v[204:207], v[40:43], v[76:79], v[204:207]
  s_add_u32 m0, s33, 50944
  s_nop 0
  buffer_load_dwordx4 v1, s[16:19], s36 offen offset:256  lds
  s_add_u32 s36, s36, 393216
  v_add_u32 v227, 24576, v224
  v_add_u32 v228, 24576, v225
  v_add_u32 v229, 24576, v226
  v_add_u32 v231, 122880, v230
  v_add_u32 v232, 131072, v230
  v_mfma_f32_16x16x32_bf16 v[152:155], v[32:35], v[80:83], v[152:155]
  s_add_u32 m0, s33, 73728
  s_nop 0
  buffer_load_dwordx4 v1, s[16:19], s36 offen  lds
  v_mfma_f32_16x16x32_bf16 v[180:183], v[36:39], v[80:83], v[180:183]
  s_add_u32 m0, s33, 74624
  s_nop 0
  buffer_load_dwordx4 v1, s[16:19], s36 offen offset:128  lds
  v_mfma_f32_16x16x32_bf16 v[208:211], v[40:43], v[80:83], v[208:211]
  s_add_u32 m0, s33, 75520
  s_nop 0
  buffer_load_dwordx4 v1, s[16:19], s36 offen offset:256  lds
  s_add_u32 s36, s36, 393216
  s_waitcnt vmcnt(9) lgkmcnt(0)
  s_barrier
  v_mfma_f32_16x16x32_bf16 v[128:131], v[44:47], v[84:87], v[128:131]
  ds_read_b64_tr_b16 v[32:33], v227
  v_mfma_f32_16x16x32_bf16 v[156:159], v[48:51], v[84:87], v[156:159]
  ds_read_b64_tr_b16 v[34:35], v227 offset:512
  s_add_u32 m0, s33, 98304
  s_nop 0
  buffer_load_dwordx4 v1, s[16:19], s36 offen  lds
  v_mfma_f32_16x16x32_bf16 v[184:187], v[52:55], v[84:87], v[184:187]
  ds_read_b64_tr_b16 v[36:37], v228
  v_mfma_f32_16x16x32_bf16 v[132:135], v[44:47], v[88:91], v[132:135]
  ds_read_b64_tr_b16 v[38:39], v228 offset:512
  s_add_u32 m0, s33, 99200
  s_nop 0
  buffer_load_dwordx4 v1, s[16:19], s36 offen offset:128  lds
  v_mfma_f32_16x16x32_bf16 v[160:163], v[48:51], v[88:91], v[160:163]
  ds_read_b64_tr_b16 v[40:41], v229
  v_mfma_f32_16x16x32_bf16 v[188:191], v[52:55], v[88:91], v[188:191]
  ds_read_b64_tr_b16 v[42:43], v229 offset:512
  s_add_u32 m0, s33, 100096
  s_nop 0
  buffer_load_dwordx4 v1, s[16:19], s36 offen offset:256  lds
  s_add_u32 s36, s36, 393216
  v_mfma_f32_16x16x32_bf16 v[136:139], v[44:47], v[92:95], v[136:139]
  ds_read_b128 v[56:59], v231 offset:0
  v_mfma_f32_16x16x32_bf16 v[164:167], v[48:51], v[92:95], v[164:167]
  ds_read_b128 v[60:63], v231 offset:2048
  s_add_u32 s45, s37, -36864
  s_add_u32 m0, s33, 0
  s_nop 0
  buffer_load_dwordx4 v2, s[8:11], s45 offen nt lds
  v_mfma_f32_16x16x32_bf16 v[192:195], v[52:55], v[92:95], v[192:195]
  ds_read_b128 v[64:67], v231 offset:4096
  v_mfma_f32_16x16x32_bf16 v[140:143], v[44:47], v[96:99], v[140:143]
  ds_read_b128 v[68:71], v231 offset:6144
  s_add_u32 m0, s33, 896
  s_nop 0
  buffer_load_dwordx4 v2, s[8:11], s45 offen offset:128 nt lds
  v_mfma_f32_16x16x32_bf16 v[168:171], v[48:51], v[96:99], v[168:171]
  ds_read_b128 v[72:75], v232 offset:0
  v_mfma_f32_16x16x32_bf16 v[196:199], v[52:55], v[96:99], v[196:199]
  ds_read_b128 v[76:79], v232 offset:2048
  s_add_u32 m0, s33, 1792
  s_nop 0
  buffer_load_dwordx4 v2, s[8:11], s45 offen offset:256 nt lds
  v_mfma_f32_16x16x32_bf16 v[144:147], v[44:47], v[100:103], v[144:147]
  ds_read_b128 v[80:83], v232 offset:4096
  v_mfma_f32_16x16x32_bf16 v[172:175], v[48:51], v[100:103], v[172:175]
  v_mfma_f32_16x16x32_bf16 v[200:203], v[52:55], v[100:103], v[200:203]
  v_mfma_f32_16x16x32_bf16 v[148:151], v[44:47], v[104:107], v[148:151]
  v_mfma_f32_16x16x32_bf16 v[176:179], v[48:51], v[104:107], v[176:179]
  v_mfma_f32_16x16x32_bf16 v[204:207], v[52:55], v[104:107], v[204:207]
  v_add_u32 v227, 49152, v224
  v_add_u32 v228, 49152, v225
  v_add_u32 v229, 49152, v226
  v_xor_b32 v231, 64, v231
  v_xor_b32 v232, 64, v232
  v_mfma_f32_16x16x32_bf16 v[152:155], v[44:47], v[108:111], v[152:155]
  v_mfma_f32_16x16x32_bf16 v[180:183], v[48:51], v[108:111], v[180:183]
  v_mfma_f32_16x16x32_bf16 v[208:211], v[52:55], v[108:111], v[208:211]
  s_waitcnt vmcnt(9) lgkmcnt(0)
  s_barrier
  v_mfma_f32_16x16x32_bf16 v[128:131], v[32:35], v[56:59], v[128:131]
  ds_read_b64_tr_b16 v[44:45], v227
  v_mfma_f32_16x16x32_bf16 v[156:159], v[36:39], v[56:59], v[156:159]
  ds_read_b64_tr_b16 v[46:47], v227 offset:512
  v_mfma_f32_16x16x32_bf16 v[184:187], v[40:43], v[56:59], v[184:187]
  ds_read_b64_tr_b16 v[48:49], v228
  v_mfma_f32_16x16x32_bf16 v[132:135], v[32:35], v[60:63], v[132:135]
  ds_read_b64_tr_b16 v[50:51], v228 offset:512
  v_mfma_f32_16x16x32_bf16 v[160:163], v[36:39], v[60:63], v[160:163]
  ds_read_b64_tr_b16 v[52:53], v229
  v_mfma_f32_16x16x32_bf16 v[188:191], v[40:43], v[60:63], v[188:191]
  ds_read_b64_tr_b16 v[54:55], v229 offset:512
  v_mfma_f32_16x16x32_bf16 v[136:139], v[32:35], v[64:67], v[136:139]
  ds_read_b128 v[84:87], v231 offset:0
  v_mfma_f32_16x16x32_bf16 v[164:167], v[36:39], v[64:67], v[164:167]
  ds_read_b128 v[88:91], v231 offset:2048
  v_mfma_f32_16x16x32_bf16 v[192:195], v[40:43], v[64:67], v[192:195]
  ds_read_b128 v[92:95], v231 offset:4096
  v_mfma_f32_16x16x32_bf16 v[140:143], v[32:35], v[68:71], v[140:143]
  ds_read_b128 v[96:99], v231 offset:6144
  v_mfma_f32_16x16x32_bf16 v[168:171], v[36:39], v[68:71], v[168:171]
  ds_read_b128 v[100:103], v232 offset:0
  v_mfma_f32_16x16x32_bf16 v[196:199], v[40:43], v[68:71], v[196:199]
  ds_read_b128 v[104:107], v232 offset:2048
  v_mfma_f32_16x16x32_bf16 v[144:147], v[32:35], v[72:75], v[144:147]
  ds_read_b128 v[108:111], v232 offset:4096
  v_mfma_f32_16x16x32_bf16 v[172:175], v[36:39], v[72:75], v[172:175]
  s_add_u32 s45, s37, -24576
  s_add_u32 m0, s33, 24576
  s_nop 0
  buffer_load_dwordx4 v2, s[8:11], s45 offen nt lds
  v_mfma_f32_16x16x32_bf16 v[200:203], v[40:43], v[72:75], v[200:203]
  v_mfma_f32_16x16x32_bf16 v[148:151], v[32:35], v[76:79], v[148:151]
  s_add_u32 m0, s33, 25472
  s_nop 0
  buffer_load_dwordx4 v2, s[8:11], s45 offen offset:128 nt lds
  v_mfma_f32_16x16x32_bf16 v[176:179], v[36:39], v[76:79], v[176:179]
  v_mfma_f32_16x16x32_bf16 v[204:207], v[40:43], v[76:79], v[204:207]
  s_add_u32 m0, s33, 26368
  s_nop 0
  buffer_load_dwordx4 v2, s[8:11], s45 offen offset:256 nt lds
  v_add_u32 v227, 73728, v224
  v_add_u32 v228, 73728, v225
  v_add_u32 v229, 73728, v226
  v_add_u32 v231, 139264, v230
  v_add_u32 v232, 147456, v230
  v_mfma_f32_16x16x32_bf16 v[152:155], v[32:35], v[80:83], v[152:155]
  v_mfma_f32_16x16x32_bf16 v[180:183], v[36:39], v[80:83], v[180:183]
  v_mfma_f32_16x16x32_bf16 v[208:211], v[40:43], v[80:83], v[208:211]
  s_waitcnt vmcnt(9) lgkmcnt(0)
  s_barrier
  v_mfma_f32_16x16x32_bf16 v[128:131], v[44:47], v[84:87], v[128:131]
  ds_read_b64_tr_b16 v[32:33], v227
  v_mfma_f32_16x16x32_bf16 v[156:159], v[48:51], v[84:87], v[156:159]
  ds_read_b64_tr_b16 v[34:35], v227 offset:512
  v_mfma_f32_16x16x32_bf16 v[184:187], v[52:55], v[84:87], v[184:187]
  ds_read_b64_tr_b16 v[36:37], v228
  v_mfma_f32_16x16x32_bf16 v[132:135], v[44:47], v[88:91], v[132:135]
  ds_read_b64_tr_b16 v[38:39], v228 offset:512
  v_mfma_f32_16x16x32_bf16 v[160:163], v[48:51], v[88:91], v[160:163]
  ds_read_b64_tr_b16 v[40:41], v229
  v_mfma_f32_16x16x32_bf16 v[188:191], v[52:55], v[88:91], v[188:191]
  ds_read_b64_tr_b16 v[42:43], v229 offset:512
  v_mfma_f32_16x16x32_bf16 v[136:139], v[44:47], v[92:95], v[136:139]
  ds_read_b128 v[56:59], v231 offset:0
  v_mfma_f32_16x16x32_bf16 v[164:167], v[48:51], v[92:95], v[164:167]
  ds_read_b128 v[60:63], v231 offset:2048
  v_mfma_f32_16x16x32_bf16 v[192:195], v[52:55], v[92:95], v[192:195]
  ds_read_b128 v[64:67], v231 offset:4096
  v_mfma_f32_16x16x32_bf16 v[140:143], v[44:47], v[96:99], v[140:143]
  ds_read_b128 v[68:71], v231 offset:6144
  v_mfma_f32_16x16x32_bf16 v[168:171], v[48:51], v[96:99], v[168:171]
  ds_read_b128 v[72:75], v232 offset:0
  v_mfma_f32_16x16x32_bf16 v[196:199], v[52:55], v[96:99], v[196:199]
  ds_read_b128 v[76:79], v232 offset:2048
  v_mfma_f32_16x16x32_bf16 v[144:147], v[44:47], v[100:103], v[144:147]
  ds_read_b128 v[80:83], v232 offset:4096
  v_mfma_f32_16x16x32_bf16 v[172:175], v[48:51], v[100:103], v[172:175]
  s_add_u32 m0, s33, 49152
  s_nop 0
  buffer_load_dwordx4 v3, s[12:15], s56 offen nt lds
  v_mfma_f32_16x16x32_bf16 v[200:203], v[52:55], v[100:103], v[200:203]
  v_mfma_f32_16x16x32_bf16 v[148:151], v[44:47], v[104:107], v[148:151]
  s_add_u32 m0, s33, 50048
  s_nop 0
  buffer_load_dwordx4 v3, s[12:15], s56 offen offset:128 nt lds
  v_mfma_f32_16x16x32_bf16 v[176:179], v[48:51], v[104:107], v[176:179]
  v_mfma_f32_16x16x32_bf16 v[204:207], v[52:55], v[104:107], v[204:207]
  s_add_u32 m0, s33, 50944
  s_nop 0
  buffer_load_dwordx4 v3, s[12:15], s56 offen offset:256 nt lds
  s_add_u32 s56, s56, 12288
  v_add_u32 v227, 98304, v224
  v_add_u32 v228, 98304, v225
  v_add_u32 v229, 98304, v226
  v_xor_b32 v231, 64, v231
  v_xor_b32 v232, 64, v232
  v_mfma_f32_16x16x32_bf16 v[152:155], v[44:47], v[108:111], v[152:155]
  v_mfma_f32_16x16x32_bf16 v[180:183], v[48:51], v[108:111], v[180:183]
  v_mfma_f32_16x16x32_bf16 v[208:211], v[52:55], v[108:111], v[208:211]
  s_waitcnt vmcnt(9) lgkmcnt(0)
  s_barrier
  v_mfma_f32_16x16x32_bf16 v[128:131], v[32:35], v[56:59], v[128:131]
  ds_read_b64_tr_b16 v[44:45], v227
  v_mfma_f32_16x16x32_bf16 v[156:159], v[36:39], v[56:59], v[156:159]
  ds_read_b64_tr_b16 v[46:47], v227 offset:512
  v_mfma_f32_16x16x32_bf16 v[184:187], v[40:43], v[56:59], v[184:187]
  ds_read_b64_tr_b16 v[48:49], v228
  v_mfma_f32_16x16x32_bf16 v[132:135], v[32:35], v[60:63], v[132:135]
  ds_read_b64_tr_b16 v[50:51], v228 offset:512
  v_mfma_f32_16x16x32_bf16 v[160:163], v[36:39], v[60:63], v[160:163]
  ds_read_b64_tr_b16 v[52:53], v229
  v_mfma_f32_16x16x32_bf16 v[188:191], v[40:43], v[60:63], v[188:191]
  ds_read_b64_tr_b16 v[54:55], v229 offset:512
  v_mfma_f32_16x16x32_bf16 v[136:139], v[32:35], v[64:67], v[136:139]
  ds_read_b128 v[84:87], v231 offset:0
  v_mfma_f32_16x16x32_bf16 v[164:167], v[36:39], v[64:67], v[164:167]
  ds_read_b128 v[88:91], v231 offset:2048
  v_mfma_f32_16x16x32_bf16 v[192:195], v[40:43], v[64:67], v[192:195]
  ds_read_b128 v[92:95], v231 offset:4096
  v_mfma_f32_16x16x32_bf16 v[140:143], v[32:35], v[68:71], v[140:143]
  ds_read_b128 v[96:99], v231 offset:6144
  v_mfma_f32_16x16x32_bf16 v[168:171], v[36:39], v[68:71], v[168:171]
  ds_read_b128 v[100:103], v232 offset:0
  v_mfma_f32_16x16x32_bf16 v[196:199], v[40:43], v[68:71], v[196:199]
  ds_read_b128 v[104:107], v232 offset:2048
  v_mfma_f32_16x16x32_bf16 v[144:147], v[32:35], v[72:75], v[144:147]
  ds_read_b128 v[108:111], v232 offset:4096
  v_mfma_f32_16x16x32_bf16 v[172:175], v[36:39], v[72:75], v[172:175]
  v_mfma_f32_16x16x32_bf16 v[200:203], v[40:43], v[72:75], v[200:203]
  v_mfma_f32_16x16x32_bf16 v[148:151], v[32:35], v[76:79], v[148:151]
  v_mfma_f32_16x16x32_bf16 v[176:179], v[36:39], v[76:79], v[176:179]
  v_mfma_f32_16x16x32_bf16 v[204:207], v[40:43], v[76:79], v[204:207]
  v_mfma_f32_16x16x32_bf16 v[152:155], v[32:35], v[80:83], v[152:155]
  v_mfma_f32_16x16x32_bf16 v[180:183], v[36:39], v[80:83], v[180:183]
  v_mfma_f32_16x16x32_bf16 v[208:211], v[40:43], v[80:83], v[208:211]
  s_waitcnt lgkmcnt(0)
  s_barrier
  v_mov_b32 v27, s42
  v_mfma_f32_16x16x32_bf16 v[128:131], v[44:47], v[84:87], v[128:131]
  v_mfma_f32_16x16x32_bf16 v[132:135], v[44:47], v[88:91], v[132:135]
  v_mfma_f32_16x16x32_bf16 v[136:139], v[44:47], v[92:95], v[136:139]
  v_mfma_f32_16x16x32_bf16 v[140:143], v[44:47], v[96:99], v[140:143]
  v_mfma_f32_16x16x32_bf16 v[144:147], v[44:47], v[100:103], v[144:147]
  v_mfma_f32_16x16x32_bf16 v[148:151], v[44:47], v[104:107], v[148:151]
  v_mfma_f32_16x16x32_bf16 v[152:155], v[44:47], v[108:111], v[152:155]
  v_mfma_f32_16x16x32_bf16 v[156:159], v[48:51], v[84:87], v[156:159]
  v_mfma_f32_16x16x32_bf16 v[160:163], v[48:51], v[88:91], v[160:163]
  s_nop 5
  v_mfma_f32_16x16x32_bf16 v[164:167], v[48:51], v[92:95], v[164:167]
  v_mul_f32 v128, s42, v128
  v_mul_f32 v129, s42, v129
  v_mul_f32 v130, s42, v130
  v_mul_f32 v131, s42, v131
  v_cvt_pk_bf16_f32 v128, v128, v129
  v_cvt_pk_bf16_f32 v129, v130, v131
  ds_write_b64 v235, v[128:129] offset:0
  v_mfma_f32_16x16x32_bf16 v[168:171], v[48:51], v[96:99], v[168:171]
  v_mul_f32 v132, s42, v132
  v_mul_f32 v133, s42, v133
  v_mul_f32 v134, s42, v134
  v_mul_f32 v135, s42, v135
  v_cvt_pk_bf16_f32 v132, v132, v133
  v_cvt_pk_bf16_f32 v133, v134, v135
  ds_write_b64 v235, v[132:133] offset:12288
  v_mfma_f32_16x16x32_bf16 v[172:175], v[48:51], v[100:103], v[172:175]
  v_mul_f32 v136, s42, v136
  v_mul_f32 v137, s42, v137
  v_mul_f32 v138, s42, v138
  v_mul_f32 v139, s42, v139
  v_cvt_pk_bf16_f32 v136, v136, v137
  v_cvt_pk_bf16_f32 v137, v138, v139
  ds_write_b64 v235, v[136:137] offset:24576
  v_mfma_f32_16x16x32_bf16 v[176:179], v[48:51], v[104:107], v[176:179]
  v_mul_f32 v140, s42, v140
  v_mul_f32 v141, s42, v141
  v_mul_f32 v142, s42, v142
  v_mul_f32 v143, s42, v143
  v_cvt_pk_bf16_f32 v140, v140, v141
  v_cvt_pk_bf16_f32 v141, v142, v143
  ds_write_b64 v235, v[140:141] offset:36864
  v_mfma_f32_16x16x32_bf16 v[180:183], v[48:51], v[108:111], v[180:183]
  v_mul_f32 v144, s42, v144
  v_mul_f32 v145, s42, v145
  v_mul_f32 v146, s42, v146
  v_mul_f32 v147, s42, v147
  v_cvt_pk_bf16_f32 v144, v144, v145
  v_cvt_pk_bf16_f32 v145, v146, v147
  ds_write_b64 v236, v[144:145] offset:0
  v_mfma_f32_16x16x32_bf16 v[184:187], v[52:55], v[84:87], v[184:187]
  v_mul_f32 v148, s42, v148
  v_mul_f32 v149, s42, v149
  v_mul_f32 v150, s42, v150
  v_mul_f32 v151, s42, v151
  v_cvt_pk_bf16_f32 v148, v148, v149
  v_cvt_pk_bf16_f32 v149, v150, v151
  ds_write_b64 v236, v[148:149] offset:12288
  v_mfma_f32_16x16x32_bf16 v[188:191], v[52:55], v[88:91], v[188:191]
  v_mul_f32 v152, s42, v152
  v_mul_f32 v153, s42, v153
  v_mul_f32 v154, s42, v154
  v_mul_f32 v155, s42, v155
  v_cvt_pk_bf16_f32 v152, v152, v153
  v_cvt_pk_bf16_f32 v153, v154, v155
  ds_write_b64 v236, v[152:153] offset:24576
  buffer_load_dwordx4 v[240:243], v2, s[8:11], s78 offen offset:0 nt
  buffer_load_dwordx4 v[244:247], v2, s[8:11], s78 offen offset:128 nt
  buffer_load_dwordx4 v[248:251], v2, s[8:11], s78 offen offset:256 nt
  v_mfma_f32_16x16x32_bf16 v[192:195], v[52:55], v[92:95], v[192:195]
  v_mul_f32 v156, s42, v156
  v_mul_f32 v157, s42, v157
  v_mul_f32 v158, s42, v158
  v_mul_f32 v159, s42, v159
  v_cvt_pk_bf16_f32 v156, v156, v157
  v_cvt_pk_bf16_f32 v157, v158, v159
  ds_write_b64 v235, v[156:157] offset:512
  v_mfma_f32_16x16x32_bf16 v[196:199], v[52:55], v[96:99], v[196:199]
  v_mul_f32 v160, s42, v160
  v_mul_f32 v161, s42, v161
  v_mul_f32 v162, s42, v162
  v_mul_f32 v163, s42, v163
  v_cvt_pk_bf16_f32 v160, v160, v161
  v_cvt_pk_bf16_f32 v161, v162, v163
  ds_write_b64 v235, v[160:161] offset:12800
  v_mfma_f32_16x16x32_bf16 v[200:203], v[52:55], v[100:103], v[200:203]
  v_mul_f32 v164, s42, v164
  v_mul_f32 v165, s42, v165
  v_mul_f32 v166, s42, v166
  v_mul_f32 v167, s42, v167
  v_cvt_pk_bf16_f32 v164, v164, v165
  v_cvt_pk_bf16_f32 v165, v166, v167
  ds_write_b64 v235, v[164:165] offset:25088
  v_mfma_f32_16x16x32_bf16 v[204:207], v[52:55], v[104:107], v[204:207]
  v_mul_f32 v168, s42, v168
  v_mul_f32 v169, s42, v169
  v_mul_f32 v170, s42, v170
  v_mul_f32 v171, s42, v171
  v_cvt_pk_bf16_f32 v168, v168, v169
  v_cvt_pk_bf16_f32 v169, v170, v171
  ds_write_b64 v235, v[168:169] offset:37376
  v_mfma_f32_16x16x32_bf16 v[208:211], v[52:55], v[108:111], v[208:211]
  v_mul_f32 v172, s42, v172
  v_mul_f32 v173, s42, v173
  v_mul_f32 v174, s42, v174
  v_mul_f32 v175, s42, v175
  v_cvt_pk_bf16_f32 v172, v172, v173
  v_cvt_pk_bf16_f32 v173, v174, v175
  ds_write_b64 v236, v[172:173] offset:512
  v_mul_f32 v176, s42, v176
  v_mul_f32 v177, s42, v177
  v_mul_f32 v178, s42, v178
  v_mul_f32 v179, s42, v179
  v_cvt_pk_bf16_f32 v176, v176, v177
  v_cvt_pk_bf16_f32 v177, v178, v179
  ds_write_b64 v236, v[176:177] offset:12800
  v_mul_f32 v180, s42, v180
  v_mul_f32 v181, s42, v181
  v_mul_f32 v182, s42, v182
  v_mul_f32 v183, s42, v183
  v_cvt_pk_bf16_f32 v180, v180, v181
  v_cvt_pk_bf16_f32 v181, v182, v183
  ds_write_b64 v236, v[180:181] offset:25088
  v_mul_f32 v184, s42, v184
  v_mul_f32 v185, s42, v185
  v_mul_f32 v186, s42, v186
  v_mul_f32 v187, s42, v187
  v_cvt_pk_bf16_f32 v184, v184, v185
  v_cvt_pk_bf16_f32 v185, v186, v187
  ds_write_b64 v235, v[184:185] offset:1024
  v_mul_f32 v188, s42, v188
  v_mul_f32 v189, s42, v189
  v_mul_f32 v190, s42, v190
  v_mul_f32 v191, s42, v191
  v_cvt_pk_bf16_f32 v188, v188, v189
  v_cvt_pk_bf16_f32 v189, v190, v191
  s_waitcnt lgkmcnt(12)
  ds_write_b64 v235, v[188:189] offset:13312
  v_mul_f32 v192, s42, v192
  v_mul_f32 v193, s42, v193
  v_mul_f32 v194, s42, v194
  v_mul_f32 v195, s42, v195
  v_cvt_pk_bf16_f32 v192, v192, v193
  v_cvt_pk_bf16_f32 v193, v194, v195
  ds_write_b64 v235, v[192:193] offset:25600
  v_mul_f32 v196, s42, v196
  v_mul_f32 v197, s42, v197
  v_mul_f32 v198, s42, v198
  v_mul_f32 v199, s42, v199
  v_cvt_pk_bf16_f32 v196, v196, v197
  v_cvt_pk_bf16_f32 v197, v198, v199
  ds_write_b64 v235, v[196:197] offset:37888
  v_mul_f32 v200, s42, v200
  v_mul_f32 v201, s42, v201
  v_mul_f32 v202, s42, v202
  v_mul_f32 v203, s42, v203
  v_cvt_pk_bf16_f32 v200, v200, v201
  v_cvt_pk_bf16_f32 v201, v202, v203
  s_waitcnt lgkmcnt(12)
  ds_write_b64 v236, v[200:201] offset:1024
  v_mul_f32 v204, s42, v204
  v_mul_f32 v205, s42, v205
  v_mul_f32 v206, s42, v206
  v_mul_f32 v207, s42, v207
  v_cvt_pk_bf16_f32 v204, v204, v205
  v_cvt_pk_bf16_f32 v205, v206, v207
  ds_write_b64 v236, v[204:205] offset:13312
  v_mul_f32 v208, s42, v208
  v_mul_f32 v209, s42, v209
  v_mul_f32 v210, s42, v210
  v_mul_f32 v211, s42, v211
  v_cvt_pk_bf16_f32 v208, v208, v209
  v_cvt_pk_bf16_f32 v209, v210, v211
  ds_write_b64 v236, v[208:209] offset:25600
  v_mov_b32 v72, 0
  v_mov_b32 v73, 0
  v_mov_b32 v74, 0
  v_mov_b32 v75, 0
  v_mov_b32 v76, 0
  v_mov_b32 v77, 0
  v_mov_b32 v78, 0
  v_mov_b32 v79, 0
  s_mov_b32 s41, 0
  s_and_b32 s47, s31, 7
  s_add_u32 s86, s47, 1
  s_add_u32 s87, s86, 1
  s_lshl_b32 s59, 1, s86
  s_or_b32 s59, s59, 16384
  s_cmp_eq_u32 s30, 3
  s_cbranch_scc1 L_p1b
  s_waitcnt vmcnt(9) lgkmcnt(0)
  s_barrier
  ds_read_b128 v[80:83], v237 offset:0
  ds_read_b128 v[104:107], v237 offset:12288
  ds_read_b128 v[84:87], v237 offset:1024
  ds_read_b128 v[108:111], v237 offset:13312
  ds_read_b128 v[88:91], v237 offset:2048
  ds_read_b128 v[112:115], v237 offset:14336
  ds_read_b128 v[92:95], v237 offset:3072
  ds_read_b128 v[116:119], v237 offset:15360
  ds_read_b128 v[96:99], v237 offset:4096
  ds_read_b128 v[120:123], v237 offset:16384
  ds_read_b128 v[100:103], v237 offset:5120
  ds_read_b128 v[124:127], v237 offset:17408
  ds_read_b128 v[32:35], v14 offset:0
  ds_read_b128 v[36:39], v14 offset:6144
  ds_read_b128 v[40:43], v15 offset:0
  v_mov_b32 v128, 0
  v_mov_b32 v129, 0
  v_mov_b32 v130, 0
  v_mov_b32 v131, 0
  v_mov_b32 v132, 0
  v_mov_b32 v133, 0
  v_mov_b32 v134, 0
  v_mov_b32 v135, 0
  v_mov_b32 v136, 0
  v_mov_b32 v137, 0
  v_mov_b32 v138, 0
  v_mov_b32 v139, 0
  v_mov_b32 v140, 0
  v_mov_b32 v141, 0
  v_mov_b32 v142, 0
  v_mov_b32 v143, 0
  v_mov_b32 v144, 0
  v_mov_b32 v145, 0
  v_mov_b32 v146, 0
  v_mov_b32 v147, 0
  v_mov_b32 v148, 0
  v_mov_b32 v149, 0
  v_mov_b32 v150, 0
  v_mov_b32 v151, 0
  s_waitcnt lgkmcnt(3)
  s_barrier
  ds_read_b128 v[44:47], v15 offset:6144
  ds_read_b128 v[48:51], v14 offset:1024
  ds_read_b128 v[52:55], v14 offset:7168
  s_waitcnt lgkmcnt(5)
  v_mfma_f32_16x16x32_bf16 v[56:59], v[32:35], v[80:83], 0
  v_mfma_f32_16x16x32_bf16 v[64:67], v[32:35], v[104:107], 0
  ds_read_b128 v[32:35], v15 offset:1024
  s_add_u32 m0, s33, 98304
  s_nop 0
  buffer_load_dwordx4 v3, s[12:15], s56 offen nt lds
  v_mov_b32 v152, 0
  v_mov_b32 v153, 0
  v_mov_b32 v154, 0
  v_mov_b32 v155, 0
  v_mov_b32 v156, 0
  v_mov_b32 v157, 0
  s_waitcnt lgkmcnt(5)
  v_mfma_f32_16x16x32_bf16 v[60:63], v[36:39], v[80:83], 0
  v_mfma_f32_16x16x32_bf16 v[68:71], v[36:39], v[104:107], 0
  ds_read_b128 v[36:39], v15 offset:7168
  s_add_u32 m0, s33, 99200
  s_nop 0
  buffer_load_dwordx4 v3, s[12:15], s56 offen offset:128 nt lds
  v_mov_b32 v158, 0
  v_mov_b32 v159, 0
  v_mov_b32 v160, 0
  v_mov_b32 v161, 0
  v_mov_b32 v162, 0
  v_mov_b32 v163, 0
  s_waitcnt lgkmcnt(5)
  v_mfma_f32_16x16x32_bf16 v[56:59], v[40:43], v[84:87], v[56:59]
  v_mfma_f32_16x16x32_bf16 v[64:67], v[40:43], v[108:111], v[64:67]
  ds_read_b128 v[40:43], v14 offset:2048
  s_add_u32 m0, s33, 100096
  s_nop 0
  buffer_load_dwordx4 v3, s[12:15], s56 offen offset:256 nt lds
  s_add_u32 s56, s56, 12288
  v_mov_b32 v164, 0
  v_mov_b32 v165, 0
  v_mov_b32 v166, 0
  v_mov_b32 v167, 0
  v_mov_b32 v168, 0
  v_mov_b32 v169, 0
  s_waitcnt lgkmcnt(5)
  v_mfma_f32_16x16x32_bf16 v[60:63], v[44:47], v[84:87], v[60:63]
  v_mfma_f32_16x16x32_bf16 v[68:71], v[44:47], v[108:111], v[68:71]
  ds_read_b128 v[44:47], v14 offset:8192
  v_mov_b32 v170, 0
  v_mov_b32 v171, 0
  v_mov_b32 v172, 0
  v_mov_b32 v173, 0
  v_mov_b32 v174, 0
  v_mov_b32 v175, 0
  s_waitcnt lgkmcnt(5)
  v_mfma_f32_16x16x32_bf16 v[56:59], v[48:51], v[88:91], v[56:59]
  v_mfma_f32_16x16x32_bf16 v[64:67], v[48:51], v[112:115], v[64:67]
  ds_read_b128 v[48:51], v15 offset:2048
  v_mov_b32 v176, 0
  v_mov_b32 v177, 0
  v_mov_b32 v178, 0
  v_mov_b32 v179, 0
  v_mov_b32 v180, 0
  v_mov_b32 v181, 0
  s_waitcnt lgkmcnt(5)
  v_mfma_f32_16x16x32_bf16 v[60:63], v[52:55], v[88:91], v[60:63]
  v_mfma_f32_16x16x32_bf16 v[68:71], v[52:55], v[112:115], v[68:71]
  ds_read_b128 v[52:55], v15 offset:8192
  v_mov_b32 v182, 0
  v_mov_b32 v183, 0
  v_mov_b32 v184, 0
  v_mov_b32 v185, 0
  v_mov_b32 v186, 0
  v_mov_b32 v187, 0
  s_waitcnt lgkmcnt(5)
  v_mfma_f32_16x16x32_bf16 v[56:59], v[32:35], v[92:95], v[56:59]
  v_mfma_f32_16x16x32_bf16 v[64:67], v[32:35], v[116:119], v[64:67]
  v_mov_b32 v188, 0
  v_mov_b32 v189, 0
  v_mov_b32 v190, 0
  v_mov_b32 v191, 0
  v_mov_b32 v192, 0
  v_mov_b32 v193, 0
  s_waitcnt lgkmcnt(4)
  v_mfma_f32_16x16x32_bf16 v[60:63], v[36:39], v[92:95], v[60:63]
  v_mfma_f32_16x16x32_bf16 v[68:71], v[36:39], v[116:119], v[68:71]
  v_mov_b32 v194, 0
  v_mov_b32 v195, 0
  v_mov_b32 v196, 0
  v_mov_b32 v197, 0
  v_mov_b32 v198, 0
  v_mov_b32 v199, 0
  s_waitcnt lgkmcnt(3)
  v_mfma_f32_16x16x32_bf16 v[56:59], v[40:43], v[96:99], v[56:59]
  v_mfma_f32_16x16x32_bf16 v[64:67], v[40:43], v[120:123], v[64:67]
  v_mov_b32 v200, 0
  v_mov_b32 v201, 0
  v_mov_b32 v202, 0
  v_mov_b32 v203, 0
  v_mov_b32 v204, 0
  v_mov_b32 v205, 0
  s_waitcnt lgkmcnt(2)
  v_mfma_f32_16x16x32_bf16 v[60:63], v[44:47], v[96:99], v[60:63]
  v_mfma_f32_16x16x32_bf16 v[68:71], v[44:47], v[120:123], v[68:71]
  v_mov_b32 v206, 0
  v_mov_b32 v207, 0
  v_mov_b32 v208, 0
  v_mov_b32 v209, 0
  v_mov_b32 v210, 0
  v_mov_b32 v211, 0
  s_waitcnt lgkmcnt(1)
  v_mfma_f32_16x16x32_bf16 v[56:59], v[48:51], v[100:103], v[56:59]
  v_mfma_f32_16x16x32_bf16 v[64:67], v[48:51], v[124:127], v[64:67]
  v_mov_b32 v212, 0
  v_mov_b32 v213, 0
  v_mov_b32 v214, 0
  v_mov_b32 v215, 0
  v_mov_b32 v216, 0
  v_mov_b32 v217, 0
  s_waitcnt lgkmcnt(0)
  v_mfma_f32_16x16x32_bf16 v[60:63], v[52:55], v[100:103], v[60:63]
  v_mfma_f32_16x16x32_bf16 v[68:71], v[52:55], v[124:127], v[68:71]
  v_mov_b32 v218, 0
  v_mov_b32 v219, 0
  v_mov_b32 v220, 0
  v_mov_b32 v221, 0
  v_mov_b32 v222, 0
  v_mov_b32 v223, 0
  s_waitcnt vmcnt(3)
  ds_write_b128 v238, v[240:243] offset:0
  ds_write_b128 v238, v[244:247] offset:1024
  ds_write_b128 v238, v[248:251] offset:2048
  s_add_u32 s35, s35, 24576
  s_cmp_eq_u32 s35, s50
  s_cselect_b32 s35, s48, s35
  v_add_u32 v14, s35, v12
  v_xor_b32 v15, 64, v14
  v_max3_f32 v23, v56, v57, v58
  v_max3_f32 v24, v64, v65, v66
  v_max3_f32 v25, v59, v60, v61
  v_max3_f32 v26, v67, v68, v69
  v_max3_f32 v23, v23, v62, v63
  v_max3_f32 v24, v24, v70, v71
  v_max_f32 v23, v23, v25
  v_max_f32 v24, v24, v26
  s_waitcnt lgkmcnt(0)
  v_mov_b32 v25, v23
  s_nop 1
  v_permlane32_swap_b32 v23, v25
  v_max_f32 v23, v23, v25
  v_mov_b32 v25, v23
  s_nop 1
  v_permlane16_swap_b32 v23, v25
  v_max_f32 v23, v23, v25
  v_sub_f32 v248, 0, v23
  v_sub_f32 v249, 0, v23
  v_sub_f32 v250, 0, v23
  v_sub_f32 v251, 0, v23
  v_sub_f32 v56, v56, v23
  v_sub_f32 v57, v57, v23
  v_sub_f32 v58, v58, v23
  v_sub_f32 v59, v59, v23
  v_sub_f32 v60, v60, v23
  v_sub_f32 v61, v61, v23
  v_sub_f32 v62, v62, v23
  v_sub_f32 v63, v63, v23
  v_mov_b32 v25, v24
  s_nop 1
  v_permlane32_swap_b32 v24, v25
  v_max_f32 v24, v24, v25
  v_mov_b32 v25, v24
  s_nop 1
  v_permlane16_swap_b32 v24, v25
  v_max_f32 v24, v24, v25
  v_sub_f32 v252, 0, v24
  v_sub_f32 v253, 0, v24
  v_sub_f32 v254, 0, v24
  v_sub_f32 v255, 0, v24
  v_sub_f32 v64, v64, v24
  v_sub_f32 v65, v65, v24
  v_sub_f32 v66, v66, v24
  v_sub_f32 v67, v67, v24
  v_sub_f32 v68, v68, v24
  v_sub_f32 v69, v69, v24
  v_sub_f32 v70, v70, v24
  v_sub_f32 v71, v71, v24
  v_exp_f32 v224, v56
  v_exp_f32 v225, v57
  v_exp_f32 v226, v58
  v_exp_f32 v227, v59
  v_exp_f32 v228, v60
  v_exp_f32 v229, v61
  v_exp_f32 v230, v62
  v_exp_f32 v231, v63
  v_exp_f32 v232, v64
  v_exp_f32 v233, v65
  v_mov_b32 v240, 0
  v_mov_b32 v241, 0
  v_mov_b32 v242, 0
  v_mov_b32 v243, 0
  v_mov_b32 v244, 0
  v_mov_b32 v245, 0
  v_mov_b32 v246, 0
  v_mov_b32 v247, 0
L_p1a_loop:
  s_cmp_lt_u32 s41, s87
  s_cbranch_scc1 L_hka
  s_waitcnt vmcnt(3)
L_hka:
  s_waitcnt vmcnt(9) lgkmcnt(0)
  s_barrier
  v_mfma_f32_16x16x32_bf16 v[192:195], v[40:43], v[72:75], v[192:195]
  ds_read_b128 v[32:35], v14 offset:0
  ds_read_b128 v[36:39], v14 offset:6144
  v_exp_f32 v234, v66
  v_mfma_f32_16x16x32_bf16 v[196:199], v[40:43], v[76:79], v[196:199]
  ds_read_b128 v[40:43], v15 offset:0
  v_exp_f32 v235, v67
  v_mfma_f32_16x16x32_bf16 v[200:203], v[44:47], v[72:75], v[200:203]
  v_exp_f32 v236, v68
  v_mfma_f32_16x16x32_bf16 v[204:207], v[44:47], v[76:79], v[204:207]
  ds_read_b128 v[44:47], v15 offset:6144
  v_exp_f32 v237, v69
  s_bitcmp1_b32 s59, s41
  s_cbranch_scc1 L_ika0_alt
  s_mov_b32 m0, s34
  s_nop 0
  buffer_load_dwordx4 v2, s[8:11], s37 offen nt lds
L_ika0_ret:
  v_mfma_f32_16x16x32_bf16 v[208:211], v[48:51], v[72:75], v[208:211]
  v_exp_f32 v238, v70
  v_mfma_f32_16x16x32_bf16 v[212:215], v[48:51], v[76:79], v[212:215]
  ds_read_b128 v[48:51], v14 offset:1024
  v_exp_f32 v239, v71
  v_mfma_f32_16x16x32_bf16 v[216:219], v[52:55], v[72:75], v[216:219]
  v_mfma_f32_16x16x32_bf16 v[220:223], v[52:55], v[76:79], v[220:223]
  ds_read_b128 v[52:55], v14 offset:7168
  s_waitcnt lgkmcnt(5)
  v_mfma_f32_16x16x32_bf16 v[56:59], v[32:35], v[80:83], v[248:251]
  v_cvt_pk_bf16_f32 v72, v224, v225
  v_mfma_f32_16x16x32_bf16 v[64:67], v[32:35], v[104:107], v[252:255]
  ds_read_b128 v[32:35], v15 offset:1024
  v_cvt_pk_bf16_f32 v73, v226, v227
  s_waitcnt lgkmcnt(5)
  v_mfma_f32_16x16x32_bf16 v[60:63], v[36:39], v[80:83], v[248:251]
  v_cvt_pk_bf16_f32 v74, v228, v229
  v_mfma_f32_16x16x32_bf16 v[68:71], v[36:39], v[104:107], v[252:255]
  ds_read_b128 v[36:39], v15 offset:7168
  v_cvt_pk_bf16_f32 v75, v230, v231
  s_bitcmp1_b32 s59, s41
  s_cbranch_scc1 L_ika1_alt
  s_add_u32 m0, s34, 896
  s_nop 0
  buffer_load_dwordx4 v2, s[8:11], s37 offen offset:128 nt lds
L_ika1_ret:
  s_waitcnt lgkmcnt(5)
  v_mfma_f32_16x16x32_bf16 v[56:59], v[40:43], v[84:87], v[56:59]
  v_mfma_f32_16x16x32_bf16 v[64:67], v[40:43], v[108:111], v[64:67]
  ds_read_b128 v[40:43], v14 offset:2048
  v_cvt_pk_bf16_f32 v76, v232, v233
  s_waitcnt lgkmcnt(5)
  v_mfma_f32_16x16x32_bf16 v[60:63], v[44:47], v[84:87], v[60:63]
  v_cvt_pk_bf16_f32 v77, v234, v235
  v_mfma_f32_16x16x32_bf16 v[68:71], v[44:47], v[108:111], v[68:71]
  ds_read_b128 v[44:47], v14 offset:8192
  v_cvt_pk_bf16_f32 v78, v236, v237
  s_waitcnt lgkmcnt(5)
  v_mfma_f32_16x16x32_bf16 v[56:59], v[48:51], v[88:91], v[56:59]
  v_cvt_pk_bf16_f32 v79, v238, v239
  v_mfma_f32_16x16x32_bf16 v[64:67], v[48:51], v[112:115], v[64:67]
  ds_read_b128 v[48:51], v15 offset:2048
  s_waitcnt lgkmcnt(5)
  v_mfma_f32_16x16x32_bf16 v[60:63], v[52:55], v[88:91], v[60:63]
  v_mfma_f32_16x16x32_bf16 v[68:71], v[52:55], v[112:115], v[68:71]
  ds_read_b128 v[52:55], v15 offset:8192
  s_bitcmp1_b32 s59, s41
  s_cbranch_scc1 L_ika2_alt
  s_add_u32 m0, s34, 1792
  s_nop 0
  buffer_load_dwordx4 v2, s[8:11], s37 offen offset:256 nt lds
  s_add_u32 s37, s37, 12288
  s_add_u32 s34, s34, 24576
  s_cmp_eq_u32 s34, s58
  s_cselect_b32 s34, s33, s34
L_ika2_ret:
  s_waitcnt lgkmcnt(5)
  v_mfma_f32_16x16x32_bf16 v[56:59], v[32:35], v[92:95], v[56:59]
  s_cmp_eq_u32 s41, s82
  s_cbranch_scc1 L_non
L_non_ret:
  v_mfma_f32_16x16x32_bf16 v[64:67], v[32:35], v[116:119], v[64:67]
  s_add_u32 s35, s35, 24576
  s_cmp_eq_u32 s35, s50
  s_cselect_b32 s35, s48, s35
  v_add_u32 v17, s35, v16
  v_xor_b32 v18, 32, v17
  v_xor_b32 v19, 64, v17
  v_xor_b32 v20, 96, v17
  s_waitcnt lgkmcnt(4)
  v_mfma_f32_16x16x32_bf16 v[60:63], v[36:39], v[92:95], v[60:63]
  v_mfma_f32_16x16x32_bf16 v[68:71], v[36:39], v[116:119], v[68:71]
  s_cmp_lg_u32 s57, 0
  s_cbranch_scc1 L_rare2a
L_rare2a_reta:
  v_mfma_f32_16x16x32_bf16 v[240:243], v[8:11], v[72:75], v[240:243]
  v_mfma_f32_16x16x32_bf16 v[244:247], v[8:11], v[76:79], v[244:247]
  s_cmp_lt_u32 s41, s86
  s_cbranch_scc1 L_hva
  s_waitcnt vmcnt(3)
L_hva:
  s_waitcnt vmcnt(9) lgkmcnt(0)
  s_barrier
  v_mfma_f32_16x16x32_bf16 v[56:59], v[40:43], v[96:99], v[56:59]
  ds_read_b64_tr_b16 v[32:33], v17 offset:0
  ds_read_b64_tr_b16 v[34:35], v17 offset:6144
  ds_read_b64_tr_b16 v[36:37], v18 offset:0
  ds_read_b64_tr_b16 v[38:39], v18 offset:6144
  v_mfma_f32_16x16x32_bf16 v[64:67], v[40:43], v[120:123], v[64:67]
  ds_read_b64_tr_b16 v[40:41], v19 offset:0
  ds_read_b64_tr_b16 v[42:43], v19 offset:6144
  s_bitcmp1_b32 s59, s41
  s_cbranch_scc1 L_iva0_alt
  s_mov_b32 m0, s34
  s_nop 0
  buffer_load_dwordx4 v3, s[12:15], s56 offen nt lds
L_iva0_ret:
  v_mfma_f32_16x16x32_bf16 v[60:63], v[44:47], v[96:99], v[60:63]
  v_mfma_f32_16x16x32_bf16 v[68:71], v[44:47], v[120:123], v[68:71]
  ds_read_b64_tr_b16 v[44:45], v20 offset:0
  ds_read_b64_tr_b16 v[46:47], v20 offset:6144
  v_mfma_f32_16x16x32_bf16 v[56:59], v[48:51], v[100:103], v[56:59]
  v_mfma_f32_16x16x32_bf16 v[64:67], v[48:51], v[124:127], v[64:67]
  ds_read_b64_tr_b16 v[48:49], v17 offset:1024
  ds_read_b64_tr_b16 v[50:51], v17 offset:7168
  s_bitcmp1_b32 s59, s41
  s_cbranch_scc1 L_iva1_alt
  s_add_u32 m0, s34, 896
  s_nop 0
  buffer_load_dwordx4 v3, s[12:15], s56 offen offset:128 nt lds
L_iva1_ret:
  v_mfma_f32_16x16x32_bf16 v[60:63], v[52:55], v[100:103], v[60:63]
  v_mfma_f32_16x16x32_bf16 v[68:71], v[52:55], v[124:127], v[68:71]
  ds_read_b64_tr_b16 v[52:53], v18 offset:1024
  ds_read_b64_tr_b16 v[54:55], v18 offset:7168
  s_waitcnt lgkmcnt(10)
  v_mfma_f32_16x16x32_bf16 v[128:131], v[32:35], v[72:75], v[128:131]
  v_mfma_f32_16x16x32_bf16 v[132:135], v[32:35], v[76:79], v[132:135]
  ds_read_b64_tr_b16 v[32:33], v19 offset:1024
  ds_read_b64_tr_b16 v[34:35], v19 offset:7168
  s_bitcmp1_b32 s59, s41
  s_cbranch_scc1 L_iva2_alt
  s_add_u32 m0, s34, 1792
  s_nop 0
  buffer_load_dwordx4 v3, s[12:15], s56 offen offset:256 nt lds
  s_add_u32 s56, s56, 12288
  s_add_u32 s34, s34, 24576
  s_cmp_eq_u32 s34, s58
  s_cselect_b32 s34, s33, s34
L_iva2_ret:
  s_waitcnt lgkmcnt(10)
  v_mfma_f32_16x16x32_bf16 v[136:139], v[36:39], v[72:75], v[136:139]
  v_max3_f32 v23, v56, v57, v58
  v_max3_f32 v24, v64, v65, v66
  v_max3_f32 v25, v59, v60, v61
  v_mfma_f32_16x16x32_bf16 v[140:143], v[36:39], v[76:79], v[140:143]
  ds_read_b64_tr_b16 v[36:37], v20 offset:1024
  ds_read_b64_tr_b16 v[38:39], v20 offset:7168
  v_max3_f32 v26, v67, v68, v69
  v_max3_f32 v23, v23, v62, v63
  s_waitcnt lgkmcnt(10)
  v_mfma_f32_16x16x32_bf16 v[144:147], v[40:43], v[72:75], v[144:147]
  v_max3_f32 v24, v24, v70, v71
  v_max_f32 v23, v23, v25
  v_max_f32 v24, v24, v26
  v_mfma_f32_16x16x32_bf16 v[148:151], v[40:43], v[76:79], v[148:151]
  ds_read_b64_tr_b16 v[40:41], v17 offset:2048
  ds_read_b64_tr_b16 v[42:43], v17 offset:8192
  v_max_f32 v25, v23, v24
  v_cmp_lt_f32 vcc, 0x40c00000, v25
  s_waitcnt lgkmcnt(10)
  v_mfma_f32_16x16x32_bf16 v[152:155], v[44:47], v[72:75], v[152:155]
  s_cbranch_vccnz L_rare1a
L_rare1a_ret:
  v_exp_f32 v224, v56
  v_mfma_f32_16x16x32_bf16 v[156:159], v[44:47], v[76:79], v[156:159]
  ds_read_b64_tr_b16 v[44:45], v18 offset:2048
  ds_read_b64_tr_b16 v[46:47], v18 offset:8192
  v_exp_f32 v225, v57
  s_waitcnt lgkmcnt(10)
  v_mfma_f32_16x16x32_bf16 v[160:163], v[48:51], v[72:75], v[160:163]
  v_exp_f32 v226, v58
  v_mfma_f32_16x16x32_bf16 v[164:167], v[48:51], v[76:79], v[164:167]
  ds_read_b64_tr_b16 v[48:49], v19 offset:2048
  ds_read_b64_tr_b16 v[50:51], v19 offset:8192
  v_exp_f32 v227, v59
  s_waitcnt lgkmcnt(10)
  v_mfma_f32_16x16x32_bf16 v[168:171], v[52:55], v[72:75], v[168:171]
  v_exp_f32 v228, v60
  v_mfma_f32_16x16x32_bf16 v[172:175], v[52:55], v[76:79], v[172:175]
  ds_read_b64_tr_b16 v[52:53], v20 offset:2048
  ds_read_b64_tr_b16 v[54:55], v20 offset:8192
  v_exp_f32 v229, v61
  s_waitcnt lgkmcnt(10)
  v_mfma_f32_16x16x32_bf16 v[176:179], v[32:35], v[72:75], v[176:179]
  v_exp_f32 v230, v62
  v_mfma_f32_16x16x32_bf16 v[180:183], v[32:35], v[76:79], v[180:183]
  s_add_u32 s35, s35, 24576
  s_cmp_eq_u32 s35, s50
  s_cselect_b32 s35, s48, s35
  v_exp_f32 v231, v63
  v_add_u32 v14, s35, v12
  v_xor_b32 v15, 64, v14
  s_waitcnt lgkmcnt(8)
  v_mfma_f32_16x16x32_bf16 v[184:187], v[36:39], v[72:75], v[184:187]
  v_exp_f32 v232, v64
  v_mfma_f32_16x16x32_bf16 v[188:191], v[36:39], v[76:79], v[188:191]
  v_exp_f32 v233, v65
  s_add_u32 s41, s41, 1
  s_cmp_lt_u32 s41, 15
  s_cbranch_scc1 L_p1a_loop
  s_waitcnt lgkmcnt(0)
  v_mfma_f32_16x16x32_bf16 v[192:195], v[40:43], v[72:75], v[192:195]
  v_exp_f32 v234, v66
  v_mfma_f32_16x16x32_bf16 v[196:199], v[40:43], v[76:79], v[196:199]
  v_exp_f32 v235, v67
  v_mfma_f32_16x16x32_bf16 v[200:203], v[44:47], v[72:75], v[200:203]
  v_exp_f32 v236, v68
  v_mfma_f32_16x16x32_bf16 v[204:207], v[44:47], v[76:79], v[204:207]
  v_exp_f32 v237, v69
  v_mfma_f32_16x16x32_bf16 v[208:211], v[48:51], v[72:75], v[208:211]
  v_exp_f32 v238, v70
  v_mfma_f32_16x16x32_bf16 v[212:215], v[48:51], v[76:79], v[212:215]
  v_exp_f32 v239, v71
  v_mfma_f32_16x16x32_bf16 v[216:219], v[52:55], v[72:75], v[216:219]
  v_mfma_f32_16x16x32_bf16 v[220:223], v[52:55], v[76:79], v[220:223]
  s_nop 0
  v_cvt_pk_bf16_f32 v72, v224, v225
  v_cvt_pk_bf16_f32 v73, v226, v227
  v_cvt_pk_bf16_f32 v74, v228, v229
  v_cvt_pk_bf16_f32 v75, v230, v231
  v_cvt_pk_bf16_f32 v76, v232, v233
  v_cvt_pk_bf16_f32 v77, v234, v235
  v_cvt_pk_bf16_f32 v78, v236, v237
  v_cvt_pk_bf16_f32 v79, v238, v239
  s_cmp_lg_u32 s57, 0
  s_cbranch_scc1 L_rare2a
L_rare2a_retb:
  v_mfma_f32_16x16x32_bf16 v[240:243], v[8:11], v[72:75], v[240:243]
  v_mfma_f32_16x16x32_bf16 v[244:247], v[8:11], v[76:79], v[244:247]
  s_cmp_lg_u32 s28, 0
  s_cbranch_scc1 L_nonw
  s_mov_b32 s78, 0
L_nonchk:
  v_readfirstlane_b32 s80, v28
  s_cmp_lg_u32 s80, 0
  s_cbranch_scc1 L_nonok
  buffer_load_dword v28, v27, s[72:75], s77 offen sc1
  s_add_u32 s78, s78, 1
  s_sleep 8
  s_waitcnt vmcnt(0)
  s_cmp_lt_u32 s78, 0x100000
  s_cbranch_scc1 L_nonchk
L_nonok:
  v_mov_b32 v29, 163824
  ds_write_b32 v29, v28
L_nonw:
  v_mov_b32 v27, 163824
  v_add_u32 v17, s35, v16
  v_xor_b32 v18, 32, v17
  v_xor_b32 v19, 64, v17
  v_xor_b32 v20, 96, v17
  v_lshrrev_b32 v23, 2, v0
  v_lshlrev_b32 v23, 7, v23
  v_and_b32 v24, 1, v0
  v_lshl_add_u32 v23, v24, 3, v23
  v_bfe_u32 v24, v0, 3, 2
  v_lshlrev_b32 v24, 1, v24
  v_bfe_u32 v25, v0, 1, 1
  v_or_b32 v24, v24, v25
  v_lshl_add_u32 v23, v24, 4, v23
  s_and_b32 s47, s30, 1
  s_lshl_b32 s47, s47, 6
  v_xor_b32 v23, s47, v23
  s_lshr_b32 s47, s30, 1
  s_mul_i32 s47, s47, 12288
  v_add_u32 v2, s47, v23
  v_lshlrev_b32 v6, 4, v0
  v_rcp_f32 v21, v240
  v_rcp_f32 v22, v244
  s_add_u32 m0, s39, 73728
  s_add_u32 s45, s43, 122880
  buffer_load_dwordx4 v4, s[20:23], s45 offen  lds
  s_add_u32 m0, s39, 77824
  s_add_u32 s45, s43, 163840
  buffer_load_dwordx4 v4, s[20:23], s45 offen  lds
  s_add_u32 m0, s39, 81920
  s_add_u32 s45, s43, 204800
  buffer_load_dwordx4 v4, s[20:23], s45 offen  lds
  s_waitcnt vmcnt(6) lgkmcnt(0)
  s_barrier
  ds_read_b32 v29, v27
  ds_read_b64_tr_b16 v[32:33], v17 offset:0
  ds_read_b64_tr_b16 v[34:35], v17 offset:6144
  ds_read_b64_tr_b16 v[36:37], v18 offset:0
  ds_read_b64_tr_b16 v[38:39], v18 offset:6144
  ds_read_b64_tr_b16 v[40:41], v19 offset:0
  ds_read_b64_tr_b16 v[42:43], v19 offset:6144
  ds_read_b64_tr_b16 v[44:45], v20 offset:0
  ds_read_b64_tr_b16 v[46:47], v20 offset:6144
  ds_read_b64_tr_b16 v[48:49], v17 offset:1024
  ds_read_b64_tr_b16 v[50:51], v17 offset:7168
  ds_read_b64_tr_b16 v[52:53], v18 offset:1024
  ds_read_b64_tr_b16 v[54:55], v18 offset:7168
  buffer_load_dword v9, v30, s[20:23], s51 offen
  s_waitcnt lgkmcnt(10)
  v_mfma_f32_16x16x32_bf16 v[128:131], v[32:35], v[72:75], v[128:131]
  v_mfma_f32_16x16x32_bf16 v[132:135], v[32:35], v[76:79], v[132:135]
  ds_read_b64_tr_b16 v[32:33], v19 offset:1024
  ds_read_b64_tr_b16 v[34:35], v19 offset:7168
  s_waitcnt lgkmcnt(10)
  v_mfma_f32_16x16x32_bf16 v[136:139], v[36:39], v[72:75], v[136:139]
  v_mfma_f32_16x16x32_bf16 v[140:143], v[36:39], v[76:79], v[140:143]
  ds_read_b64_tr_b16 v[36:37], v20 offset:1024
  ds_read_b64_tr_b16 v[38:39], v20 offset:7168
  s_waitcnt lgkmcnt(10)
  v_mfma_f32_16x16x32_bf16 v[144:147], v[40:43], v[72:75], v[144:147]
  v_mfma_f32_16x16x32_bf16 v[148:151], v[40:43], v[76:79], v[148:151]
  ds_read_b64_tr_b16 v[40:41], v17 offset:2048
  ds_read_b64_tr_b16 v[42:43], v17 offset:8192
  s_waitcnt lgkmcnt(10)
  v_mfma_f32_16x16x32_bf16 v[152:155], v[44:47], v[72:75], v[152:155]
  v_mfma_f32_16x16x32_bf16 v[156:159], v[44:47], v[76:79], v[156:159]
  ds_read_b64_tr_b16 v[44:45], v18 offset:2048
  ds_read_b64_tr_b16 v[46:47], v18 offset:8192
  v_mul_f32 v128, v128, v21
  v_mul_f32 v129, v129, v21
  v_mul_f32 v130, v130, v21
  v_mul_f32 v131, v131, v21
  v_cvt_pk_bf16_f32 v80, v128, v129
  v_cvt_pk_bf16_f32 v81, v130, v131
  v_mul_f32 v136, v136, v21
  v_mul_f32 v137, v137, v21
  v_mul_f32 v138, v138, v21
  v_mul_f32 v139, v139, v21
  v_cvt_pk_bf16_f32 v82, v136, v137
  v_cvt_pk_bf16_f32 v83, v138, v139
  ds_write_b128 v31, v[80:83] offset:0
  v_mul_f32 v132, v132, v22
  v_mul_f32 v133, v133, v22
  v_mul_f32 v134, v134, v22
  v_mul_f32 v135, v135, v22
  v_cvt_pk_bf16_f32 v84, v132, v133
  v_cvt_pk_bf16_f32 v85, v134, v135
  v_mul_f32 v140, v140, v22
  v_mul_f32 v141, v141, v22
  v_mul_f32 v142, v142, v22
  v_mul_f32 v143, v143, v22
  v_cvt_pk_bf16_f32 v86, v140, v141
  v_cvt_pk_bf16_f32 v87, v142, v143
  ds_write_b128 v31, v[84:87] offset:12288
  s_waitcnt lgkmcnt(12)
  v_mfma_f32_16x16x32_bf16 v[160:163], v[48:51], v[72:75], v[160:163]
  v_mfma_f32_16x16x32_bf16 v[164:167], v[48:51], v[76:79], v[164:167]
  ds_read_b64_tr_b16 v[48:49], v19 offset:2048
  ds_read_b64_tr_b16 v[50:51], v19 offset:8192
  s_waitcnt lgkmcnt(12)
  v_mfma_f32_16x16x32_bf16 v[168:171], v[52:55], v[72:75], v[168:171]
  v_mfma_f32_16x16x32_bf16 v[172:175], v[52:55], v[76:79], v[172:175]
  ds_read_b64_tr_b16 v[52:53], v20 offset:2048
  ds_read_b64_tr_b16 v[54:55], v20 offset:8192
  v_mul_f32 v144, v144, v21
  v_mul_f32 v145, v145, v21
  v_mul_f32 v146, v146, v21
  v_mul_f32 v147, v147, v21
  v_cvt_pk_bf16_f32 v88, v144, v145
  v_cvt_pk_bf16_f32 v89, v146, v147
  v_mul_f32 v152, v152, v21
  v_mul_f32 v153, v153, v21
  v_mul_f32 v154, v154, v21
  v_mul_f32 v155, v155, v21
  v_cvt_pk_bf16_f32 v90, v152, v153
  v_cvt_pk_bf16_f32 v91, v154, v155
  ds_write_b128 v31, v[88:91] offset:1024
  v_mul_f32 v148, v148, v22
  v_mul_f32 v149, v149, v22
  v_mul_f32 v150, v150, v22
  v_mul_f32 v151, v151, v22
  v_cvt_pk_bf16_f32 v92, v148, v149
  v_cvt_pk_bf16_f32 v93, v150, v151
  v_mul_f32 v156, v156, v22
  v_mul_f32 v157, v157, v22
  v_mul_f32 v158, v158, v22
  v_mul_f32 v159, v159, v22
  v_cvt_pk_bf16_f32 v94, v156, v157
  v_cvt_pk_bf16_f32 v95, v158, v159
  s_waitcnt lgkmcnt(12)
  ds_write_b128 v31, v[92:95] offset:13312
  v_mfma_f32_16x16x32_bf16 v[176:179], v[32:35], v[72:75], v[176:179]
  v_mfma_f32_16x16x32_bf16 v[180:183], v[32:35], v[76:79], v[180:183]
  s_waitcnt lgkmcnt(12)
  v_mfma_f32_16x16x32_bf16 v[184:187], v[36:39], v[72:75], v[184:187]
  v_mfma_f32_16x16x32_bf16 v[188:191], v[36:39], v[76:79], v[188:191]
  v_mul_f32 v160, v160, v21
  v_mul_f32 v161, v161, v21
  v_mul_f32 v162, v162, v21
  v_mul_f32 v163, v163, v21
  v_cvt_pk_bf16_f32 v96, v160, v161
  v_cvt_pk_bf16_f32 v97, v162, v163
  v_mul_f32 v168, v168, v21
  v_mul_f32 v169, v169, v21
  v_mul_f32 v170, v170, v21
  v_mul_f32 v171, v171, v21
  v_cvt_pk_bf16_f32 v98, v168, v169
  v_cvt_pk_bf16_f32 v99, v170, v171
  ds_write_b128 v31, v[96:99] offset:2048
  v_mul_f32 v164, v164, v22
  v_mul_f32 v165, v165, v22
  v_mul_f32 v166, v166, v22
  v_mul_f32 v167, v167, v22
  v_cvt_pk_bf16_f32 v100, v164, v165
  v_cvt_pk_bf16_f32 v101, v166, v167
  v_mul_f32 v172, v172, v22
  v_mul_f32 v173, v173, v22
  v_mul_f32 v174, v174, v22
  v_mul_f32 v175, v175, v22
  v_cvt_pk_bf16_f32 v102, v172, v173
  v_cvt_pk_bf16_f32 v103, v174, v175
  ds_write_b128 v31, v[100:103] offset:14336
  s_waitcnt lgkmcnt(12)
  v_mfma_f32_16x16x32_bf16 v[192:195], v[40:43], v[72:75], v[192:195]
  v_mfma_f32_16x16x32_bf16 v[196:199], v[40:43], v[76:79], v[196:199]
  s_waitcnt lgkmcnt(10)
  v_mfma_f32_16x16x32_bf16 v[200:203], v[44:47], v[72:75], v[200:203]
  v_mfma_f32_16x16x32_bf16 v[204:207], v[44:47], v[76:79], v[204:207]
  v_mul_f32 v176, v176, v21
  v_mul_f32 v177, v177, v21
  v_mul_f32 v178, v178, v21
  v_mul_f32 v179, v179, v21
  v_cvt_pk_bf16_f32 v104, v176, v177
  v_cvt_pk_bf16_f32 v105, v178, v179
  v_mul_f32 v184, v184, v21
  v_mul_f32 v185, v185, v21
  v_mul_f32 v186, v186, v21
  v_mul_f32 v187, v187, v21
  v_cvt_pk_bf16_f32 v106, v184, v185
  v_cvt_pk_bf16_f32 v107, v186, v187
  ds_write_b128 v31, v[104:107] offset:3072
  v_mul_f32 v180, v180, v22
  v_mul_f32 v181, v181, v22
  v_mul_f32 v182, v182, v22
  v_mul_f32 v183, v183, v22
  v_cvt_pk_bf16_f32 v108, v180, v181
  v_cvt_pk_bf16_f32 v109, v182, v183
  v_mul_f32 v188, v188, v22
  v_mul_f32 v189, v189, v22
  v_mul_f32 v190, v190, v22
  v_mul_f32 v191, v191, v22
  v_cvt_pk_bf16_f32 v110, v188, v189
  v_cvt_pk_bf16_f32 v111, v190, v191
  ds_write_b128 v31, v[108:111] offset:15360
  s_waitcnt lgkmcnt(8)
  v_mfma_f32_16x16x32_bf16 v[208:211], v[48:51], v[72:75], v[208:211]
  v_mfma_f32_16x16x32_bf16 v[212:215], v[48:51], v[76:79], v[212:215]
  s_waitcnt lgkmcnt(6)
  v_mfma_f32_16x16x32_bf16 v[216:219], v[52:55], v[72:75], v[216:219]
  v_mfma_f32_16x16x32_bf16 v[220:223], v[52:55], v[76:79], v[220:223]
  v_mul_f32 v192, v192, v21
  v_mul_f32 v193, v193, v21
  v_mul_f32 v194, v194, v21
  v_mul_f32 v195, v195, v21
  v_cvt_pk_bf16_f32 v112, v192, v193
  v_cvt_pk_bf16_f32 v113, v194, v195
  v_mul_f32 v200, v200, v21
  v_mul_f32 v201, v201, v21
  v_mul_f32 v202, v202, v21
  v_mul_f32 v203, v203, v21
  v_cvt_pk_bf16_f32 v114, v200, v201
  v_cvt_pk_bf16_f32 v115, v202, v203
  ds_write_b128 v31, v[112:115] offset:4096
  v_mul_f32 v196, v196, v22
  v_mul_f32 v197, v197, v22
  v_mul_f32 v198, v198, v22
  v_mul_f32 v199, v199, v22
  v_cvt_pk_bf16_f32 v116, v196, v197
  v_cvt_pk_bf16_f32 v117, v198, v199
  v_mul_f32 v204, v204, v22
  v_mul_f32 v205, v205, v22
  v_mul_f32 v206, v206, v22
  v_mul_f32 v207, v207, v22
  v_cvt_pk_bf16_f32 v118, v204, v205
  v_cvt_pk_bf16_f32 v119, v206, v207
  ds_write_b128 v31, v[116:119] offset:16384
  v_mul_f32 v208, v208, v21
  v_mul_f32 v209, v209, v21
  v_mul_f32 v210, v210, v21
  v_mul_f32 v211, v211, v21
  v_cvt_pk_bf16_f32 v120, v208, v209
  v_cvt_pk_bf16_f32 v121, v210, v211
  v_mul_f32 v216, v216, v21
  v_mul_f32 v217, v217, v21
  v_mul_f32 v218, v218, v21
  v_mul_f32 v219, v219, v21
  v_cvt_pk_bf16_f32 v122, v216, v217
  v_cvt_pk_bf16_f32 v123, v218, v219
  ds_write_b128 v31, v[120:123] offset:5120
  v_mul_f32 v212, v212, v22
  v_mul_f32 v213, v213, v22
  v_mul_f32 v214, v214, v22
  v_mul_f32 v215, v215, v22
  v_cvt_pk_bf16_f32 v124, v212, v213
  v_cvt_pk_bf16_f32 v125, v214, v215
  v_mul_f32 v220, v220, v22
  v_mul_f32 v221, v221, v22
  v_mul_f32 v222, v222, v22
  v_mul_f32 v223, v223, v22
  v_cvt_pk_bf16_f32 v126, v220, v221
  v_cvt_pk_bf16_f32 v127, v222, v223
  ds_write_b128 v31, v[124:127] offset:17408
  s_branch L_p1_done
L_p1b:
  s_waitcnt vmcnt(9) lgkmcnt(0)
  s_barrier
  ds_read_b128 v[80:83], v237 offset:0
  ds_read_b128 v[84:87], v237 offset:1024
  ds_read_b128 v[88:91], v237 offset:2048
  ds_read_b128 v[92:95], v237 offset:3072
  ds_read_b128 v[96:99], v237 offset:4096
  ds_read_b128 v[100:103], v237 offset:5120
  ds_read_b128 v[32:35], v14 offset:0
  ds_read_b128 v[36:39], v14 offset:6144
  ds_read_b128 v[40:43], v15 offset:0
  v_mov_b32 v128, 0
  v_mov_b32 v129, 0
  v_mov_b32 v130, 0
  v_mov_b32 v131, 0
  v_mov_b32 v132, 0
  v_mov_b32 v133, 0
  v_mov_b32 v134, 0
  v_mov_b32 v135, 0
  v_mov_b32 v136, 0
  v_mov_b32 v137, 0
  v_mov_b32 v138, 0
  v_mov_b32 v139, 0
  v_mov_b32 v140, 0
  v_mov_b32 v141, 0
  v_mov_b32 v142, 0
  v_mov_b32 v143, 0
  v_mov_b32 v144, 0
  v_mov_b32 v145, 0
  v_mov_b32 v146, 0
  v_mov_b32 v147, 0
  v_mov_b32 v148, 0
  v_mov_b32 v149, 0
  v_mov_b32 v150, 0
  v_mov_b32 v151, 0
  s_waitcnt lgkmcnt(3)
  s_barrier
  ds_read_b128 v[44:47], v15 offset:6144
  ds_read_b128 v[48:51], v14 offset:1024
  ds_read_b128 v[52:55], v14 offset:7168
  s_waitcnt lgkmcnt(5)
  v_mfma_f32_16x16x32_bf16 v[56:59], v[32:35], v[80:83], 0
  ds_read_b128 v[32:35], v15 offset:1024
  s_add_u32 m0, s33, 98304
  s_nop 0
  buffer_load_dwordx4 v3, s[12:15], s56 offen nt lds
  v_mov_b32 v152, 0
  v_mov_b32 v153, 0
  v_mov_b32 v154, 0
  v_mov_b32 v155, 0
  v_mov_b32 v156, 0
  v_mov_b32 v157, 0
  s_waitcnt lgkmcnt(5)
  v_mfma_f32_16x16x32_bf16 v[60:63], v[36:39], v[80:83], 0
  ds_read_b128 v[36:39], v15 offset:7168
  s_add_u32 m0, s33, 99200
  s_nop 0
  buffer_load_dwordx4 v3, s[12:15], s56 offen offset:128 nt lds
  v_mov_b32 v158, 0
  v_mov_b32 v159, 0
  v_mov_b32 v160, 0
  v_mov_b32 v161, 0
  v_mov_b32 v162, 0
  v_mov_b32 v163, 0
  s_waitcnt lgkmcnt(5)
  v_mfma_f32_16x16x32_bf16 v[56:59], v[40:43], v[84:87], v[56:59]
  ds_read_b128 v[40:43], v14 offset:2048
  s_add_u32 m0, s33, 100096
  s_nop 0
  buffer_load_dwordx4 v3, s[12:15], s56 offen offset:256 nt lds
  s_add_u32 s56, s56, 12288
  v_mov_b32 v164, 0
  v_mov_b32 v165, 0
  v_mov_b32 v166, 0
  v_mov_b32 v167, 0
  v_mov_b32 v168, 0
  v_mov_b32 v169, 0
  s_waitcnt lgkmcnt(5)
  v_mfma_f32_16x16x32_bf16 v[60:63], v[44:47], v[84:87], v[60:63]
  ds_read_b128 v[44:47], v14 offset:8192
  v_mov_b32 v170, 0
  v_mov_b32 v171, 0
  v_mov_b32 v172, 0
  v_mov_b32 v173, 0
  v_mov_b32 v174, 0
  v_mov_b32 v175, 0
  s_waitcnt lgkmcnt(5)
  v_mfma_f32_16x16x32_bf16 v[56:59], v[48:51], v[88:91], v[56:59]
  ds_read_b128 v[48:51], v15 offset:2048
  v_mov_b32 v176, 0
  v_mov_b32 v177, 0
  v_mov_b32 v178, 0
  v_mov_b32 v179, 0
  v_mov_b32 v180, 0
  v_mov_b32 v181, 0
  s_waitcnt lgkmcnt(5)
  v_mfma_f32_16x16x32_bf16 v[60:63], v[52:55], v[88:91], v[60:63]
  ds_read_b128 v[52:55], v15 offset:8192
  v_mov_b32 v182, 0
  v_mov_b32 v183, 0
  v_mov_b32 v184, 0
  v_mov_b32 v185, 0
  v_mov_b32 v186, 0
  v_mov_b32 v187, 0
  s_waitcnt lgkmcnt(5)
  v_mfma_f32_16x16x32_bf16 v[56:59], v[32:35], v[92:95], v[56:59]
  v_mov_b32 v188, 0
  v_mov_b32 v189, 0
  v_mov_b32 v190, 0
  v_mov_b32 v191, 0
  v_mov_b32 v192, 0
  v_mov_b32 v193, 0
  s_waitcnt lgkmcnt(4)
  v_mfma_f32_16x16x32_bf16 v[60:63], v[36:39], v[92:95], v[60:63]
  v_mov_b32 v194, 0
  v_mov_b32 v195, 0
  v_mov_b32 v196, 0
  v_mov_b32 v197, 0
  v_mov_b32 v198, 0
  v_mov_b32 v199, 0
  s_waitcnt lgkmcnt(3)
  v_mfma_f32_16x16x32_bf16 v[56:59], v[40:43], v[96:99], v[56:59]
  v_mov_b32 v200, 0
  v_mov_b32 v201, 0
  v_mov_b32 v202, 0
  v_mov_b32 v203, 0
  v_mov_b32 v204, 0
  v_mov_b32 v205, 0
  s_waitcnt lgkmcnt(2)
  v_mfma_f32_16x16x32_bf16 v[60:63], v[44:47], v[96:99], v[60:63]
  v_mov_b32 v206, 0
  v_mov_b32 v207, 0
  v_mov_b32 v208, 0
  v_mov_b32 v209, 0
  v_mov_b32 v210, 0
  v_mov_b32 v211, 0
  s_waitcnt lgkmcnt(1)
  v_mfma_f32_16x16x32_bf16 v[56:59], v[48:51], v[100:103], v[56:59]
  v_mov_b32 v212, 0
  v_mov_b32 v213, 0
  v_mov_b32 v214, 0
  v_mov_b32 v215, 0
  v_mov_b32 v216, 0
  v_mov_b32 v217, 0
  s_waitcnt lgkmcnt(0)
  v_mfma_f32_16x16x32_bf16 v[60:63], v[52:55], v[100:103], v[60:63]
  v_mov_b32 v218, 0
  v_mov_b32 v219, 0
  v_mov_b32 v220, 0
  v_mov_b32 v221, 0
  v_mov_b32 v222, 0
  v_mov_b32 v223, 0
  s_waitcnt vmcnt(3)
  ds_write_b128 v238, v[240:243] offset:0
  ds_write_b128 v238, v[244:247] offset:1024
  ds_write_b128 v238, v[248:251] offset:2048
  s_add_u32 s35, s35, 24576
  s_cmp_eq_u32 s35, s50
  s_cselect_b32 s35, s48, s35
  v_add_u32 v14, s35, v12
  v_xor_b32 v15, 64, v14
  v_max3_f32 v23, v56, v57, v58
  v_max3_f32 v25, v59, v60, v61
  v_max3_f32 v23, v23, v62, v63
  v_max_f32 v23, v23, v25
  s_waitcnt lgkmcnt(0)
  v_mov_b32 v25, v23
  s_nop 1
  v_permlane32_swap_b32 v23, v25
  v_max_f32 v23, v23, v25
  v_mov_b32 v25, v23
  s_nop 1
  v_permlane16_swap_b32 v23, v25
  v_max_f32 v23, v23, v25
  v_sub_f32 v248, 0, v23
  v_sub_f32 v249, 0, v23
  v_sub_f32 v250, 0, v23
  v_sub_f32 v251, 0, v23
  v_sub_f32 v56, v56, v23
  v_sub_f32 v57, v57, v23
  v_sub_f32 v58, v58, v23
  v_sub_f32 v59, v59, v23
  v_sub_f32 v60, v60, v23
  v_sub_f32 v61, v61, v23
  v_sub_f32 v62, v62, v23
  v_sub_f32 v63, v63, v23
  v_exp_f32 v224, v56
  v_exp_f32 v225, v57
  v_exp_f32 v226, v58
  v_exp_f32 v227, v59
  v_exp_f32 v228, v60
  v_mov_b32 v240, 0
  v_mov_b32 v241, 0
  v_mov_b32 v242, 0
  v_mov_b32 v243, 0
  v_mov_b32 v244, 0
  v_mov_b32 v245, 0
  v_mov_b32 v246, 0
  v_mov_b32 v247, 0
L_p1b_loop:
  s_cmp_lt_u32 s41, s87
  s_cbranch_scc1 L_hkb
  s_waitcnt vmcnt(3)
L_hkb:
  s_waitcnt vmcnt(9) lgkmcnt(0)
  s_barrier
  v_mfma_f32_16x16x32_bf16 v[192:195], v[40:43], v[72:75], v[192:195]
  ds_read_b128 v[32:35], v14 offset:0
  ds_read_b128 v[36:39], v14 offset:6144
  v_exp_f32 v229, v61
  ds_read_b128 v[40:43], v15 offset:0
  v_mfma_f32_16x16x32_bf16 v[200:203], v[44:47], v[72:75], v[200:203]
  v_exp_f32 v230, v62
  ds_read_b128 v[44:47], v15 offset:6144
  s_bitcmp1_b32 s59, s41
  s_cbranch_scc1 L_ikb0_alt
  s_mov_b32 m0, s34
  s_nop 0
  buffer_load_dwordx4 v2, s[8:11], s37 offen nt lds
L_ikb0_ret:
  v_mfma_f32_16x16x32_bf16 v[208:211], v[48:51], v[72:75], v[208:211]
  v_exp_f32 v231, v63
  ds_read_b128 v[48:51], v14 offset:1024
  v_mfma_f32_16x16x32_bf16 v[216:219], v[52:55], v[72:75], v[216:219]
  ds_read_b128 v[52:55], v14 offset:7168
  s_waitcnt lgkmcnt(5)
  v_mfma_f32_16x16x32_bf16 v[56:59], v[32:35], v[80:83], v[248:251]
  v_cvt_pk_bf16_f32 v72, v224, v225
  ds_read_b128 v[32:35], v15 offset:1024
  s_waitcnt lgkmcnt(5)
  v_mfma_f32_16x16x32_bf16 v[60:63], v[36:39], v[80:83], v[248:251]
  v_cvt_pk_bf16_f32 v73, v226, v227
  ds_read_b128 v[36:39], v15 offset:7168
  s_bitcmp1_b32 s59, s41
  s_cbranch_scc1 L_ikb1_alt
  s_add_u32 m0, s34, 896
  s_nop 0
  buffer_load_dwordx4 v2, s[8:11], s37 offen offset:128 nt lds
L_ikb1_ret:
  s_waitcnt lgkmcnt(5)
  v_mfma_f32_16x16x32_bf16 v[56:59], v[40:43], v[84:87], v[56:59]
  ds_read_b128 v[40:43], v14 offset:2048
  v_cvt_pk_bf16_f32 v74, v228, v229
  s_waitcnt lgkmcnt(5)
  v_mfma_f32_16x16x32_bf16 v[60:63], v[44:47], v[84:87], v[60:63]
  ds_read_b128 v[44:47], v14 offset:8192
  v_cvt_pk_bf16_f32 v75, v230, v231
  s_waitcnt lgkmcnt(5)
  v_mfma_f32_16x16x32_bf16 v[56:59], v[48:51], v[88:91], v[56:59]
  ds_read_b128 v[48:51], v15 offset:2048
  s_waitcnt lgkmcnt(5)
  v_mfma_f32_16x16x32_bf16 v[60:63], v[52:55], v[88:91], v[60:63]
  ds_read_b128 v[52:55], v15 offset:8192
  s_bitcmp1_b32 s59, s41
  s_cbranch_scc1 L_ikb2_alt
  s_add_u32 m0, s34, 1792
  s_nop 0
  buffer_load_dwordx4 v2, s[8:11], s37 offen offset:256 nt lds
  s_add_u32 s37, s37, 12288
  s_add_u32 s34, s34, 24576
  s_cmp_eq_u32 s34, s58
  s_cselect_b32 s34, s33, s34
L_ikb2_ret:
  s_waitcnt lgkmcnt(5)
  v_mfma_f32_16x16x32_bf16 v[56:59], v[32:35], v[92:95], v[56:59]
  s_add_u32 s35, s35, 24576
  s_cmp_eq_u32 s35, s50
  s_cselect_b32 s35, s48, s35
  v_add_u32 v17, s35, v16
  v_xor_b32 v18, 32, v17
  v_xor_b32 v19, 64, v17
  v_xor_b32 v20, 96, v17
  s_waitcnt lgkmcnt(4)
  v_mfma_f32_16x16x32_bf16 v[60:63], v[36:39], v[92:95], v[60:63]
  s_cmp_lg_u32 s57, 0
  s_cbranch_scc1 L_rare2b
L_rare2b_reta:
  v_mfma_f32_16x16x32_bf16 v[240:243], v[8:11], v[72:75], v[240:243]
  s_cmp_lt_u32 s41, s86
  s_cbranch_scc1 L_hvb
  s_waitcnt vmcnt(3)
L_hvb:
  s_waitcnt vmcnt(9) lgkmcnt(0)
  s_barrier
  v_mfma_f32_16x16x32_bf16 v[56:59], v[40:43], v[96:99], v[56:59]
  ds_read_b64_tr_b16 v[32:33], v17 offset:0
  ds_read_b64_tr_b16 v[34:35], v17 offset:6144
  ds_read_b64_tr_b16 v[36:37], v18 offset:0
  ds_read_b64_tr_b16 v[38:39], v18 offset:6144
  ds_read_b64_tr_b16 v[40:41], v19 offset:0
  ds_read_b64_tr_b16 v[42:43], v19 offset:6144
  s_bitcmp1_b32 s59, s41
  s_cbranch_scc1 L_ivb0_alt
  s_mov_b32 m0, s34
  s_nop 0
  buffer_load_dwordx4 v3, s[12:15], s56 offen nt lds
L_ivb0_ret:
  v_mfma_f32_16x16x32_bf16 v[60:63], v[44:47], v[96:99], v[60:63]
  ds_read_b64_tr_b16 v[44:45], v20 offset:0
  ds_read_b64_tr_b16 v[46:47], v20 offset:6144
  v_mfma_f32_16x16x32_bf16 v[56:59], v[48:51], v[100:103], v[56:59]
  ds_read_b64_tr_b16 v[48:49], v17 offset:1024
  ds_read_b64_tr_b16 v[50:51], v17 offset:7168
  s_bitcmp1_b32 s59, s41
  s_cbranch_scc1 L_ivb1_alt
  s_add_u32 m0, s34, 896
  s_nop 0
  buffer_load_dwordx4 v3, s[12:15], s56 offen offset:128 nt lds
L_ivb1_ret:
  v_mfma_f32_16x16x32_bf16 v[60:63], v[52:55], v[100:103], v[60:63]
  ds_read_b64_tr_b16 v[52:53], v18 offset:1024
  ds_read_b64_tr_b16 v[54:55], v18 offset:7168
  s_waitcnt lgkmcnt(10)
  v_mfma_f32_16x16x32_bf16 v[128:131], v[32:35], v[72:75], v[128:131]
  ds_read_b64_tr_b16 v[32:33], v19 offset:1024
  ds_read_b64_tr_b16 v[34:35], v19 offset:7168
  s_bitcmp1_b32 s59, s41
  s_cbranch_scc1 L_ivb2_alt
  s_add_u32 m0, s34, 1792
  s_nop 0
  buffer_load_dwordx4 v3, s[12:15], s56 offen offset:256 nt lds
  s_add_u32 s56, s56, 12288
  s_add_u32 s34, s34, 24576
  s_cmp_eq_u32 s34, s58
  s_cselect_b32 s34, s33, s34
L_ivb2_ret:
  s_waitcnt lgkmcnt(10)
  v_mfma_f32_16x16x32_bf16 v[136:139], v[36:39], v[72:75], v[136:139]
  v_max3_f32 v23, v56, v57, v58
  v_max3_f32 v25, v59, v60, v61
  ds_read_b64_tr_b16 v[36:37], v20 offset:1024
  ds_read_b64_tr_b16 v[38:39], v20 offset:7168
  v_max3_f32 v23, v23, v62, v63
  s_waitcnt lgkmcnt(10)
  v_mfma_f32_16x16x32_bf16 v[144:147], v[40:43], v[72:75], v[144:147]
  v_max_f32 v23, v23, v25
  ds_read_b64_tr_b16 v[40:41], v17 offset:2048
  ds_read_b64_tr_b16 v[42:43], v17 offset:8192
  v_cmp_lt_f32 vcc, 0x40c00000, v23
  s_waitcnt lgkmcnt(10)
  v_mfma_f32_16x16x32_bf16 v[152:155], v[44:47], v[72:75], v[152:155]
  s_cbranch_vccnz L_rare1b
L_rare1b_ret:
  v_exp_f32 v224, v56
  ds_read_b64_tr_b16 v[44:45], v18 offset:2048
  ds_read_b64_tr_b16 v[46:47], v18 offset:8192
  s_waitcnt lgkmcnt(10)
  v_mfma_f32_16x16x32_bf16 v[160:163], v[48:51], v[72:75], v[160:163]
  v_exp_f32 v225, v57
  ds_read_b64_tr_b16 v[48:49], v19 offset:2048
  ds_read_b64_tr_b16 v[50:51], v19 offset:8192
  s_waitcnt lgkmcnt(10)
  v_mfma_f32_16x16x32_bf16 v[168:171], v[52:55], v[72:75], v[168:171]
  v_exp_f32 v226, v58
  ds_read_b64_tr_b16 v[52:53], v20 offset:2048
  ds_read_b64_tr_b16 v[54:55], v20 offset:8192
  s_waitcnt lgkmcnt(10)
  v_mfma_f32_16x16x32_bf16 v[176:179], v[32:35], v[72:75], v[176:179]
  v_exp_f32 v227, v59
  s_add_u32 s35, s35, 24576
  s_cmp_eq_u32 s35, s50
  s_cselect_b32 s35, s48, s35
  v_add_u32 v14, s35, v12
  v_xor_b32 v15, 64, v14
  s_waitcnt lgkmcnt(8)
  v_mfma_f32_16x16x32_bf16 v[184:187], v[36:39], v[72:75], v[184:187]
  v_exp_f32 v228, v60
  s_add_u32 s41, s41, 1
  s_cmp_lt_u32 s41, 15
  s_cbranch_scc1 L_p1b_loop
  s_waitcnt lgkmcnt(0)
  v_mfma_f32_16x16x32_bf16 v[192:195], v[40:43], v[72:75], v[192:195]
  v_exp_f32 v229, v61
  v_mfma_f32_16x16x32_bf16 v[200:203], v[44:47], v[72:75], v[200:203]
  v_exp_f32 v230, v62
  v_mfma_f32_16x16x32_bf16 v[208:211], v[48:51], v[72:75], v[208:211]
  v_exp_f32 v231, v63
  v_mfma_f32_16x16x32_bf16 v[216:219], v[52:55], v[72:75], v[216:219]
  s_nop 0
  v_cvt_pk_bf16_f32 v72, v224, v225
  v_cvt_pk_bf16_f32 v73, v226, v227
  v_cvt_pk_bf16_f32 v74, v228, v229
  v_cvt_pk_bf16_f32 v75, v230, v231
  s_cmp_lg_u32 s57, 0
  s_cbranch_scc1 L_rare2b
L_rare2b_retb:
  v_mfma_f32_16x16x32_bf16 v[240:243], v[8:11], v[72:75], v[240:243]
  v_mov_b32 v27, 163824
  v_add_u32 v17, s35, v16
  v_xor_b32 v18, 32, v17
  v_xor_b32 v19, 64, v17
  v_xor_b32 v20, 96, v17
  v_lshrrev_b32 v23, 2, v0
  v_lshlrev_b32 v23, 7, v23
  v_and_b32 v24, 1, v0
  v_lshl_add_u32 v23, v24, 3, v23
  v_bfe_u32 v24, v0, 3, 2
  v_lshlrev_b32 v24, 1, v24
  v_bfe_u32 v25, v0, 1, 1
  v_or_b32 v24, v24, v25
  v_lshl_add_u32 v23, v24, 4, v23
  s_and_b32 s47, s30, 1
  s_lshl_b32 s47, s47, 6
  v_xor_b32 v23, s47, v23
  s_lshr_b32 s47, s30, 1
  s_mul_i32 s47, s47, 12288
  v_add_u32 v2, s47, v23
  v_lshlrev_b32 v6, 4, v0
  v_rcp_f32 v21, v240
  s_add_u32 m0, s39, 73728
  s_add_u32 s45, s43, 122880
  buffer_load_dwordx4 v4, s[20:23], s45 offen  lds
  s_add_u32 m0, s39, 77824
  s_add_u32 s45, s43, 163840
  buffer_load_dwordx4 v4, s[20:23], s45 offen  lds
  s_add_u32 m0, s39, 81920
  s_add_u32 s45, s43, 204800
  buffer_load_dwordx4 v4, s[20:23], s45 offen  lds
  s_waitcnt vmcnt(6) lgkmcnt(0)
  s_barrier
  ds_read_b32 v29, v27
  ds_read_b64_tr_b16 v[32:33], v17 offset:0
  ds_read_b64_tr_b16 v[34:35], v17 offset:6144
  ds_read_b64_tr_b16 v[36:37], v18 offset:0
  ds_read_b64_tr_b16 v[38:39], v18 offset:6144
  ds_read_b64_tr_b16 v[40:41], v19 offset:0
  ds_read_b64_tr_b16 v[42:43], v19 offset:6144
  ds_read_b64_tr_b16 v[44:45], v20 offset:0
  ds_read_b64_tr_b16 v[46:47], v20 offset:6144
  ds_read_b64_tr_b16 v[48:49], v17 offset:1024
  ds_read_b64_tr_b16 v[50:51], v17 offset:7168
  ds_read_b64_tr_b16 v[52:53], v18 offset:1024
  ds_read_b64_tr_b16 v[54:55], v18 offset:7168
  buffer_load_dword v9, v30, s[20:23], s51 offen
  s_waitcnt lgkmcnt(10)
  v_mfma_f32_16x16x32_bf16 v[128:131], v[32:35], v[72:75], v[128:131]
  ds_read_b64_tr_b16 v[32:33], v19 offset:1024
  ds_read_b64_tr_b16 v[34:35], v19 offset:7168
  s_waitcnt lgkmcnt(10)
  v_mfma_f32_16x16x32_bf16 v[136:139], v[36:39], v[72:75], v[136:139]
  ds_read_b64_tr_b16 v[36:37], v20 offset:1024
  ds_read_b64_tr_b16 v[38:39], v20 offset:7168
  s_waitcnt lgkmcnt(10)
  v_mfma_f32_16x16x32_bf16 v[144:147], v[40:43], v[72:75], v[144:147]
  ds_read_b64_tr_b16 v[40:41], v17 offset:2048
  ds_read_b64_tr_b16 v[42:43], v17 offset:8192
  s_waitcnt lgkmcnt(10)
  v_mfma_f32_16x16x32_bf16 v[152:155], v[44:47], v[72:75], v[152:155]
  ds_read_b64_tr_b16 v[44:45], v18 offset:2048
  ds_read_b64_tr_b16 v[46:47], v18 offset:8192
  v_mul_f32 v128, v128, v21
  v_mul_f32 v129, v129, v21
  v_mul_f32 v130, v130, v21
  v_mul_f32 v131, v131, v21
  v_cvt_pk_bf16_f32 v80, v128, v129
  v_cvt_pk_bf16_f32 v81, v130, v131
  v_mul_f32 v136, v136, v21
  v_mul_f32 v137, v137, v21
  v_mul_f32 v138, v138, v21
  v_mul_f32 v139, v139, v21
  v_cvt_pk_bf16_f32 v82, v136, v137
  v_cvt_pk_bf16_f32 v83, v138, v139
  ds_write_b128 v31, v[80:83] offset:0
  s_waitcnt lgkmcnt(11)
  v_mfma_f32_16x16x32_bf16 v[160:163], v[48:51], v[72:75], v[160:163]
  ds_read_b64_tr_b16 v[48:49], v19 offset:2048
  ds_read_b64_tr_b16 v[50:51], v19 offset:8192
  s_waitcnt lgkmcnt(11)
  v_mfma_f32_16x16x32_bf16 v[168:171], v[52:55], v[72:75], v[168:171]
  ds_read_b64_tr_b16 v[52:53], v20 offset:2048
  ds_read_b64_tr_b16 v[54:55], v20 offset:8192
  v_mul_f32 v144, v144, v21
  v_mul_f32 v145, v145, v21
  v_mul_f32 v146, v146, v21
  v_mul_f32 v147, v147, v21
  v_cvt_pk_bf16_f32 v88, v144, v145
  v_cvt_pk_bf16_f32 v89, v146, v147
  v_mul_f32 v152, v152, v21
  v_mul_f32 v153, v153, v21
  v_mul_f32 v154, v154, v21
  v_mul_f32 v155, v155, v21
  v_cvt_pk_bf16_f32 v90, v152, v153
  v_cvt_pk_bf16_f32 v91, v154, v155
  ds_write_b128 v31, v[88:91] offset:1024
  s_waitcnt lgkmcnt(12)
  v_mfma_f32_16x16x32_bf16 v[176:179], v[32:35], v[72:75], v[176:179]
  s_waitcnt lgkmcnt(10)
  v_mfma_f32_16x16x32_bf16 v[184:187], v[36:39], v[72:75], v[184:187]
  v_mul_f32 v160, v160, v21
  v_mul_f32 v161, v161, v21
  v_mul_f32 v162, v162, v21
  v_mul_f32 v163, v163, v21
  v_cvt_pk_bf16_f32 v96, v160, v161
  v_cvt_pk_bf16_f32 v97, v162, v163
  v_mul_f32 v168, v168, v21
  v_mul_f32 v169, v169, v21
  v_mul_f32 v170, v170, v21
  v_mul_f32 v171, v171, v21
  v_cvt_pk_bf16_f32 v98, v168, v169
  v_cvt_pk_bf16_f32 v99, v170, v171
  ds_write_b128 v31, v[96:99] offset:2048
  s_waitcnt lgkmcnt(9)
  v_mfma_f32_16x16x32_bf16 v[192:195], v[40:43], v[72:75], v[192:195]
  s_waitcnt lgkmcnt(7)
  v_mfma_f32_16x16x32_bf16 v[200:203], v[44:47], v[72:75], v[200:203]
  v_mul_f32 v176, v176, v21
  v_mul_f32 v177, v177, v21
  v_mul_f32 v178, v178, v21
  v_mul_f32 v179, v179, v21
  v_cvt_pk_bf16_f32 v104, v176, v177
  v_cvt_pk_bf16_f32 v105, v178, v179
  v_mul_f32 v184, v184, v21
  v_mul_f32 v185, v185, v21
  v_mul_f32 v186, v186, v21
  v_mul_f32 v187, v187, v21
  v_cvt_pk_bf16_f32 v106, v184, v185
  v_cvt_pk_bf16_f32 v107, v186, v187
  ds_write_b128 v31, v[104:107] offset:3072
  s_waitcnt lgkmcnt(5)
  v_mfma_f32_16x16x32_bf16 v[208:211], v[48:51], v[72:75], v[208:211]
  s_waitcnt lgkmcnt(3)
  v_mfma_f32_16x16x32_bf16 v[216:219], v[52:55], v[72:75], v[216:219]
  v_mul_f32 v192, v192, v21
  v_mul_f32 v193, v193, v21
  v_mul_f32 v194, v194, v21
  v_mul_f32 v195, v195, v21
  v_cvt_pk_bf16_f32 v112, v192, v193
  v_cvt_pk_bf16_f32 v113, v194, v195
  v_mul_f32 v200, v200, v21
  v_mul_f32 v201, v201, v21
  v_mul_f32 v202, v202, v21
  v_mul_f32 v203, v203, v21
  v_cvt_pk_bf16_f32 v114, v200, v201
  v_cvt_pk_bf16_f32 v115, v202, v203
  ds_write_b128 v31, v[112:115] offset:4096
  v_mul_f32 v208, v208, v21
  v_mul_f32 v209, v209, v21
  v_mul_f32 v210, v210, v21
  v_mul_f32 v211, v211, v21
  v_cvt_pk_bf16_f32 v120, v208, v209
  v_cvt_pk_bf16_f32 v121, v210, v211
  v_mul_f32 v216, v216, v21
  v_mul_f32 v217, v217, v21
  v_mul_f32 v218, v218, v21
  v_mul_f32 v219, v219, v21
  v_cvt_pk_bf16_f32 v122, v216, v217
  v_cvt_pk_bf16_f32 v123, v218, v219
  ds_write_b128 v31, v[120:123] offset:5120
L_p1_done:
  v_readfirstlane_b32 s80, v29
  s_mul_i32 s47, s29, 122880
  v_add_u32 v7, s47, v6
  s_mul_i32 s47, s29, 49152
  s_add_u32 s47, s47, 98304
  v_add_u32 v8, s47, v6
  v_lshlrev_b32 v0, 3, v0
  v_add_u32 v3, 49152, v2
  v_xor_b32 v5, 32, v3
  s_cmp_lg_u32 s29, 0
  s_cbranch_scc1 L_p2b
  s_waitcnt vmcnt(4) lgkmcnt(0)
  s_barrier
  ds_read_b128 v[64:67], v7 offset:0
  ds_read_b128 v[68:71], v7 offset:12288
  ds_read_b128 v[72:75], v8 offset:0
  ds_read_b128 v[76:79], v8 offset:12288
  ds_read_b64_tr_b16 v[16:17], v3 offset:0
  ds_read_b64_tr_b16 v[18:19], v3 offset:2048
  ds_read_b64_tr_b16 v[20:21], v5 offset:0
  ds_read_b64_tr_b16 v[22:23], v5 offset:2048
  ds_read_b64_tr_b16 v[24:25], v3 offset:4096
  ds_read_b64_tr_b16 v[26:27], v3 offset:6144
  s_waitcnt lgkmcnt(4)
  v_mfma_f32_16x16x32_bf16 v[32:35], v[16:19], v[64:67], 0
  ds_read_b128 v[80:83], v7 offset:1024
  ds_read_b128 v[84:87], v7 offset:13312
  v_mfma_f32_16x16x32_bf16 v[36:39], v[16:19], v[68:71], 0
  ds_read_b128 v[88:91], v8 offset:1024
  ds_read_b128 v[92:95], v8 offset:13312
  v_mfma_f32_16x16x32_bf16 v[40:43], v[16:19], v[72:75], 0
  ds_read_b64_tr_b16 v[28:29], v5 offset:4096
  v_mfma_f32_16x16x32_bf16 v[44:47], v[16:19], v[76:79], 0
  ds_read_b64_tr_b16 v[30:31], v5 offset:6144
  s_waitcnt lgkmcnt(8)
  v_mfma_f32_16x16x32_bf16 v[48:51], v[20:23], v[64:67], 0
  ds_read_b128 v[96:99], v7 offset:2048
  ds_read_b128 v[100:103], v7 offset:14336
  v_mfma_f32_16x16x32_bf16 v[52:55], v[20:23], v[68:71], 0
  ds_read_b128 v[104:107], v8 offset:2048
  ds_read_b128 v[108:111], v8 offset:14336
  v_mfma_f32_16x16x32_bf16 v[56:59], v[20:23], v[72:75], 0
  ds_read_b64_tr_b16 v[16:17], v3 offset:8192
  v_mfma_f32_16x16x32_bf16 v[60:63], v[20:23], v[76:79], 0
  ds_read_b64_tr_b16 v[18:19], v3 offset:10240
  s_waitcnt lgkmcnt(8)
  v_mfma_f32_16x16x32_bf16 v[32:35], v[24:27], v[80:83], v[32:35]
  ds_read_b64_tr_b16 v[20:21], v5 offset:8192
  v_mfma_f32_16x16x32_bf16 v[36:39], v[24:27], v[84:87], v[36:39]
  ds_read_b64_tr_b16 v[22:23], v5 offset:10240
  v_mfma_f32_16x16x32_bf16 v[40:43], v[24:27], v[88:91], v[40:43]
  v_add_u32 v3, 73728, v2
  v_mfma_f32_16x16x32_bf16 v[44:47], v[24:27], v[92:95], v[44:47]
  v_xor_b32 v5, 32, v3
  s_waitcnt lgkmcnt(8)
  v_mfma_f32_16x16x32_bf16 v[48:51], v[28:31], v[80:83], v[48:51]
  v_mfma_f32_16x16x32_bf16 v[52:55], v[28:31], v[84:87], v[52:55]
  v_mfma_f32_16x16x32_bf16 v[56:59], v[28:31], v[88:91], v[56:59]
  v_mfma_f32_16x16x32_bf16 v[60:63], v[28:31], v[92:95], v[60:63]
  s_waitcnt vmcnt(1) lgkmcnt(0)
  s_barrier
  v_mfma_f32_16x16x32_bf16 v[32:35], v[16:19], v[96:99], v[32:35]
  ds_read_b128 v[112:115], v7 offset:3072
  ds_read_b128 v[116:119], v7 offset:15360
  v_mfma_f32_16x16x32_bf16 v[36:39], v[16:19], v[100:103], v[36:39]
  ds_read_b128 v[120:123], v8 offset:3072
  ds_read_b128 v[124:127], v8 offset:15360
  v_mfma_f32_16x16x32_bf16 v[40:43], v[16:19], v[104:107], v[40:43]
  ds_read_b64_tr_b16 v[24:25], v3 offset:0
  ds_read_b64_tr_b16 v[26:27], v3 offset:2048
  v_mfma_f32_16x16x32_bf16 v[44:47], v[16:19], v[108:111], v[44:47]
  ds_read_b64_tr_b16 v[28:29], v5 offset:0
  ds_read_b64_tr_b16 v[30:31], v5 offset:2048
  v_mfma_f32_16x16x32_bf16 v[48:51], v[20:23], v[96:99], v[48:51]
  ds_read_b64_tr_b16 v[16:17], v3 offset:4096
  v_mfma_f32_16x16x32_bf16 v[52:55], v[20:23], v[100:103], v[52:55]
  ds_read_b64_tr_b16 v[18:19], v3 offset:6144
  v_mfma_f32_16x16x32_bf16 v[56:59], v[20:23], v[104:107], v[56:59]
  v_mfma_f32_16x16x32_bf16 v[60:63], v[20:23], v[108:111], v[60:63]
  s_waitcnt lgkmcnt(4)
  v_mfma_f32_16x16x32_bf16 v[32:35], v[24:27], v[112:115], v[32:35]
  ds_read_b128 v[128:131], v7 offset:4096
  ds_read_b128 v[132:135], v7 offset:16384
  v_mfma_f32_16x16x32_bf16 v[36:39], v[24:27], v[116:119], v[36:39]
  ds_read_b128 v[136:139], v8 offset:4096
  ds_read_b128 v[140:143], v8 offset:16384
  v_mfma_f32_16x16x32_bf16 v[40:43], v[24:27], v[120:123], v[40:43]
  ds_read_b64_tr_b16 v[20:21], v5 offset:4096
  v_mfma_f32_16x16x32_bf16 v[44:47], v[24:27], v[124:127], v[44:47]
  ds_read_b64_tr_b16 v[22:23], v5 offset:6144
  s_waitcnt lgkmcnt(8)
  v_mfma_f32_16x16x32_bf16 v[48:51], v[28:31], v[112:115], v[48:51]
  ds_read_b128 v[144:147], v7 offset:5120
  ds_read_b128 v[148:151], v7 offset:17408
  v_mfma_f32_16x16x32_bf16 v[52:55], v[28:31], v[116:119], v[52:55]
  ds_read_b128 v[152:155], v8 offset:5120
  ds_read_b128 v[156:159], v8 offset:17408
  v_mfma_f32_16x16x32_bf16 v[56:59], v[28:31], v[120:123], v[56:59]
  ds_read_b64_tr_b16 v[24:25], v3 offset:8192
  v_mfma_f32_16x16x32_bf16 v[60:63], v[28:31], v[124:127], v[60:63]
  ds_read_b64_tr_b16 v[26:27], v3 offset:10240
  s_waitcnt lgkmcnt(8)
  v_mfma_f32_16x16x32_bf16 v[32:35], v[16:19], v[128:131], v[32:35]
  ds_read_b64_tr_b16 v[28:29], v5 offset:8192
  v_mfma_f32_16x16x32_bf16 v[36:39], v[16:19], v[132:135], v[36:39]
  ds_read_b64_tr_b16 v[30:31], v5 offset:10240
  v_mfma_f32_16x16x32_bf16 v[40:43], v[16:19], v[136:139], v[40:43]
  v_add_u32 v3, 24576, v2
  v_mfma_f32_16x16x32_bf16 v[44:47], v[16:19], v[140:143], v[44:47]
  v_xor_b32 v5, 32, v3
  s_waitcnt lgkmcnt(8)
  v_mfma_f32_16x16x32_bf16 v[48:51], v[20:23], v[128:131], v[48:51]
  v_mfma_f32_16x16x32_bf16 v[52:55], v[20:23], v[132:135], v[52:55]
  v_mfma_f32_16x16x32_bf16 v[56:59], v[20:23], v[136:139], v[56:59]
  v_mfma_f32_16x16x32_bf16 v[60:63], v[20:23], v[140:143], v[60:63]
  s_waitcnt lgkmcnt(0)
  s_barrier
  v_mfma_f32_16x16x32_bf16 v[32:35], v[24:27], v[144:147], v[32:35]
  ds_read_b128 v[160:163], v7 offset:6144
  ds_read_b128 v[164:167], v7 offset:18432
  v_mfma_f32_16x16x32_bf16 v[36:39], v[24:27], v[148:151], v[36:39]
  ds_read_b128 v[168:171], v8 offset:6144
  ds_read_b128 v[172:175], v8 offset:18432
  v_mfma_f32_16x16x32_bf16 v[40:43], v[24:27], v[152:155], v[40:43]
  ds_read_b64_tr_b16 v[16:17], v3 offset:0
  ds_read_b64_tr_b16 v[18:19], v3 offset:2048
  v_mfma_f32_16x16x32_bf16 v[44:47], v[24:27], v[156:159], v[44:47]
  ds_read_b64_tr_b16 v[20:21], v5 offset:0
  ds_read_b64_tr_b16 v[22:23], v5 offset:2048
  v_mfma_f32_16x16x32_bf16 v[48:51], v[28:31], v[144:147], v[48:51]
  ds_read_b64_tr_b16 v[24:25], v3 offset:4096
  v_mfma_f32_16x16x32_bf16 v[52:55], v[28:31], v[148:151], v[52:55]
  ds_read_b64_tr_b16 v[26:27], v3 offset:6144
  v_mfma_f32_16x16x32_bf16 v[56:59], v[28:31], v[152:155], v[56:59]
  v_mfma_f32_16x16x32_bf16 v[60:63], v[28:31], v[156:159], v[60:63]
  s_waitcnt lgkmcnt(4)
  v_mfma_f32_16x16x32_bf16 v[32:35], v[16:19], v[160:163], v[32:35]
  ds_read_b128 v[176:179], v7 offset:7168
  ds_read_b128 v[180:183], v7 offset:19456
  v_mfma_f32_16x16x32_bf16 v[36:39], v[16:19], v[164:167], v[36:39]
  ds_read_b128 v[184:187], v8 offset:7168
  ds_read_b128 v[188:191], v8 offset:19456
  v_mfma_f32_16x16x32_bf16 v[40:43], v[16:19], v[168:171], v[40:43]
  ds_read_b64_tr_b16 v[28:29], v5 offset:4096
  v_mfma_f32_16x16x32_bf16 v[44:47], v[16:19], v[172:175], v[44:47]
  ds_read_b64_tr_b16 v[30:31], v5 offset:6144
  s_waitcnt lgkmcnt(8)
  v_mfma_f32_16x16x32_bf16 v[48:51], v[20:23], v[160:163], v[48:51]
  ds_read_b128 v[192:195], v7 offset:8192
  ds_read_b128 v[196:199], v7 offset:20480
  v_mfma_f32_16x16x32_bf16 v[52:55], v[20:23], v[164:167], v[52:55]
  ds_read_b128 v[200:203], v8 offset:8192
  ds_read_b128 v[204:207], v8 offset:20480
  v_mfma_f32_16x16x32_bf16 v[56:59], v[20:23], v[168:171], v[56:59]
  ds_read_b64_tr_b16 v[16:17], v3 offset:8192
  v_mfma_f32_16x16x32_bf16 v[60:63], v[20:23], v[172:175], v[60:63]
  ds_read_b64_tr_b16 v[18:19], v3 offset:10240
  s_waitcnt lgkmcnt(8)
  v_mfma_f32_16x16x32_bf16 v[32:35], v[24:27], v[176:179], v[32:35]
  ds_read_b64_tr_b16 v[20:21], v5 offset:8192
  v_mfma_f32_16x16x32_bf16 v[36:39], v[24:27], v[180:183], v[36:39]
  ds_read_b64_tr_b16 v[22:23], v5 offset:10240
  v_mfma_f32_16x16x32_bf16 v[40:43], v[24:27], v[184:187], v[40:43]
  v_add_u32 v3, 49152, v2
  v_mfma_f32_16x16x32_bf16 v[44:47], v[24:27], v[188:191], v[44:47]
  v_xor_b32 v5, 32, v3
  s_waitcnt lgkmcnt(8)
  v_mfma_f32_16x16x32_bf16 v[48:51], v[28:31], v[176:179], v[48:51]
  v_mfma_f32_16x16x32_bf16 v[52:55], v[28:31], v[180:183], v[52:55]
  v_mfma_f32_16x16x32_bf16 v[56:59], v[28:31], v[184:187], v[56:59]
  v_mfma_f32_16x16x32_bf16 v[60:63], v[28:31], v[188:191], v[60:63]
  s_waitcnt lgkmcnt(0)
  s_barrier
  v_mfma_f32_16x16x32_bf16 v[32:35], v[16:19], v[192:195], v[32:35]
  ds_read_b128 v[208:211], v7 offset:9216
  ds_read_b128 v[212:215], v7 offset:21504
  v_mfma_f32_16x16x32_bf16 v[36:39], v[16:19], v[196:199], v[36:39]
  ds_read_b128 v[216:219], v8 offset:9216
  ds_read_b128 v[220:223], v8 offset:21504
  v_mfma_f32_16x16x32_bf16 v[40:43], v[16:19], v[200:203], v[40:43]
  ds_read_b64_tr_b16 v[24:25], v3 offset:0
  ds_read_b64_tr_b16 v[26:27], v3 offset:2048
  v_mfma_f32_16x16x32_bf16 v[44:47], v[16:19], v[204:207], v[44:47]
  ds_read_b64_tr_b16 v[28:29], v5 offset:0
  ds_read_b64_tr_b16 v[30:31], v5 offset:2048
  v_mfma_f32_16x16x32_bf16 v[48:51], v[20:23], v[192:195], v[48:51]
  ds_read_b64_tr_b16 v[16:17], v3 offset:4096
  v_mfma_f32_16x16x32_bf16 v[52:55], v[20:23], v[196:199], v[52:55]
  ds_read_b64_tr_b16 v[18:19], v3 offset:6144
  v_mfma_f32_16x16x32_bf16 v[56:59], v[20:23], v[200:203], v[56:59]
  v_mfma_f32_16x16x32_bf16 v[60:63], v[20:23], v[204:207], v[60:63]
  s_waitcnt lgkmcnt(4)
  v_mfma_f32_16x16x32_bf16 v[32:35], v[24:27], v[208:211], v[32:35]
  ds_read_b128 v[224:227], v7 offset:10240
  ds_read_b128 v[228:231], v7 offset:22528
  v_mfma_f32_16x16x32_bf16 v[36:39], v[24:27], v[212:215], v[36:39]
  ds_read_b128 v[232:235], v8 offset:10240
  ds_read_b128 v[236:239], v8 offset:22528
  v_mfma_f32_16x16x32_bf16 v[40:43], v[24:27], v[216:219], v[40:43]
  ds_read_b64_tr_b16 v[20:21], v5 offset:4096
  v_mfma_f32_16x16x32_bf16 v[44:47], v[24:27], v[220:223], v[44:47]
  ds_read_b64_tr_b16 v[22:23], v5 offset:6144
  s_waitcnt lgkmcnt(8)
  v_mfma_f32_16x16x32_bf16 v[48:51], v[28:31], v[208:211], v[48:51]
  ds_read_b128 v[240:243], v7 offset:11264
  ds_read_b128 v[244:247], v7 offset:23552
  v_mfma_f32_16x16x32_bf16 v[52:55], v[28:31], v[212:215], v[52:55]
  ds_read_b128 v[248:251], v8 offset:11264
  ds_read_b128 v[252:255], v8 offset:23552
  v_mfma_f32_16x16x32_bf16 v[56:59], v[28:31], v[216:219], v[56:59]
  ds_read_b64_tr_b16 v[24:25], v3 offset:8192
  v_mfma_f32_16x16x32_bf16 v[60:63], v[28:31], v[220:223], v[60:63]
  ds_read_b64_tr_b16 v[26:27], v3 offset:10240
  s_waitcnt lgkmcnt(8)
  v_mfma_f32_16x16x32_bf16 v[32:35], v[16:19], v[224:227], v[32:35]
  ds_read_b64_tr_b16 v[28:29], v5 offset:8192
  v_mfma_f32_16x16x32_bf16 v[36:39], v[16:19], v[228:231], v[36:39]
  ds_read_b64_tr_b16 v[30:31], v5 offset:10240
  v_mfma_f32_16x16x32_bf16 v[40:43], v[16:19], v[232:235], v[40:43]
  v_add_u32 v3, 73728, v2
  v_mfma_f32_16x16x32_bf16 v[44:47], v[16:19], v[236:239], v[44:47]
  v_xor_b32 v5, 32, v3
  s_waitcnt lgkmcnt(8)
  v_mfma_f32_16x16x32_bf16 v[48:51], v[20:23], v[224:227], v[48:51]
  v_mfma_f32_16x16x32_bf16 v[52:55], v[20:23], v[228:231], v[52:55]
  v_mfma_f32_16x16x32_bf16 v[56:59], v[20:23], v[232:235], v[56:59]
  v_mfma_f32_16x16x32_bf16 v[60:63], v[20:23], v[236:239], v[60:63]
  s_waitcnt vmcnt(0) lgkmcnt(0)
  s_barrier
  v_mfma_f32_16x16x32_bf16 v[32:35], v[24:27], v[240:243], v[32:35]
  ds_read_b64_tr_b16 v[16:17], v3 offset:0
  v_mfma_f32_16x16x32_bf16 v[36:39], v[24:27], v[244:247], v[36:39]
  ds_read_b64_tr_b16 v[18:19], v3 offset:2048
  v_mfma_f32_16x16x32_bf16 v[40:43], v[24:27], v[248:251], v[40:43]
  ds_read_b64_tr_b16 v[20:21], v5 offset:0
  v_mfma_f32_16x16x32_bf16 v[44:47], v[24:27], v[252:255], v[44:47]
  ds_read_b64_tr_b16 v[22:23], v5 offset:2048
  v_mfma_f32_16x16x32_bf16 v[48:51], v[28:31], v[240:243], v[48:51]
  ds_read_b64_tr_b16 v[24:25], v3 offset:4096
  v_mfma_f32_16x16x32_bf16 v[52:55], v[28:31], v[244:247], v[52:55]
  ds_read_b64_tr_b16 v[26:27], v3 offset:6144
  v_mfma_f32_16x16x32_bf16 v[56:59], v[28:31], v[248:251], v[56:59]
  v_mfma_f32_16x16x32_bf16 v[60:63], v[28:31], v[252:255], v[60:63]
  s_waitcnt lgkmcnt(4)
  v_cvt_pk_bf16_f32 v8, v32, v33
  v_cvt_pk_bf16_f32 v9, v34, v35
  v_mfma_f32_16x16x32_bf16 v[32:35], v[16:19], v[64:67], 0
  ds_read_b64_tr_b16 v[28:29], v5 offset:4096
  v_cvt_pk_bf16_f32 v10, v36, v37
  v_cvt_pk_bf16_f32 v11, v38, v39
  v_mfma_f32_16x16x32_bf16 v[36:39], v[16:19], v[68:71], 0
  buffer_store_dwordx4 v[8:11], v6, s[24:27], s46 offen offset:0 sc1
  ds_read_b64_tr_b16 v[30:31], v5 offset:6144
  v_cvt_pk_bf16_f32 v12, v40, v41
  v_cvt_pk_bf16_f32 v13, v42, v43
  v_mfma_f32_16x16x32_bf16 v[40:43], v[16:19], v[72:75], 0
  v_cvt_pk_bf16_f32 v14, v44, v45
  v_cvt_pk_bf16_f32 v15, v46, v47
  v_mfma_f32_16x16x32_bf16 v[44:47], v[16:19], v[76:79], 0
  buffer_store_dwordx4 v[12:15], v6, s[24:27], s46 offen offset:1024 sc1
  s_waitcnt lgkmcnt(4)
  v_cvt_pk_bf16_f32 v8, v48, v49
  v_cvt_pk_bf16_f32 v9, v50, v51
  v_mfma_f32_16x16x32_bf16 v[48:51], v[20:23], v[64:67], 0
  ds_read_b64_tr_b16 v[16:17], v3 offset:8192
  v_cvt_pk_bf16_f32 v10, v52, v53
  v_cvt_pk_bf16_f32 v11, v54, v55
  v_mfma_f32_16x16x32_bf16 v[52:55], v[20:23], v[68:71], 0
  buffer_store_dwordx4 v[8:11], v6, s[24:27], s46 offen offset:2048 sc1
  ds_read_b64_tr_b16 v[18:19], v3 offset:10240
  v_cvt_pk_bf16_f32 v12, v56, v57
  v_cvt_pk_bf16_f32 v13, v58, v59
  v_mfma_f32_16x16x32_bf16 v[56:59], v[20:23], v[72:75], 0
  v_cvt_pk_bf16_f32 v14, v60, v61
  v_cvt_pk_bf16_f32 v15, v62, v63
  v_mfma_f32_16x16x32_bf16 v[60:63], v[20:23], v[76:79], 0
  buffer_store_dwordx4 v[12:15], v6, s[24:27], s46 offen offset:3072 sc1
  s_add_u32 s46, s46, 28672
  s_waitcnt lgkmcnt(4)
  v_mfma_f32_16x16x32_bf16 v[32:35], v[24:27], v[80:83], v[32:35]
  ds_read_b64_tr_b16 v[20:21], v5 offset:8192
  v_mfma_f32_16x16x32_bf16 v[36:39], v[24:27], v[84:87], v[36:39]
  ds_read_b64_tr_b16 v[22:23], v5 offset:10240
  v_mfma_f32_16x16x32_bf16 v[40:43], v[24:27], v[88:91], v[40:43]
  v_add_u32 v3, 24576, v2
  v_mfma_f32_16x16x32_bf16 v[44:47], v[24:27], v[92:95], v[44:47]
  v_xor_b32 v5, 32, v3
  s_waitcnt lgkmcnt(4)
  v_mfma_f32_16x16x32_bf16 v[48:51], v[28:31], v[80:83], v[48:51]
  v_mfma_f32_16x16x32_bf16 v[52:55], v[28:31], v[84:87], v[52:55]
  v_mfma_f32_16x16x32_bf16 v[56:59], v[28:31], v[88:91], v[56:59]
  v_mfma_f32_16x16x32_bf16 v[60:63], v[28:31], v[92:95], v[60:63]
  s_waitcnt lgkmcnt(0)
  s_barrier
  v_mfma_f32_16x16x32_bf16 v[32:35], v[16:19], v[96:99], v[32:35]
  ds_read_b64_tr_b16 v[24:25], v3 offset:0
  v_mfma_f32_16x16x32_bf16 v[36:39], v[16:19], v[100:103], v[36:39]
  ds_read_b64_tr_b16 v[26:27], v3 offset:2048
  v_mfma_f32_16x16x32_bf16 v[40:43], v[16:19], v[104:107], v[40:43]
  ds_read_b64_tr_b16 v[28:29], v5 offset:0
  v_mfma_f32_16x16x32_bf16 v[44:47], v[16:19], v[108:111], v[44:47]
  ds_read_b64_tr_b16 v[30:31], v5 offset:2048
  v_mfma_f32_16x16x32_bf16 v[48:51], v[20:23], v[96:99], v[48:51]
  ds_read_b64_tr_b16 v[16:17], v3 offset:4096
  v_mfma_f32_16x16x32_bf16 v[52:55], v[20:23], v[100:103], v[52:55]
  ds_read_b64_tr_b16 v[18:19], v3 offset:6144
  v_mfma_f32_16x16x32_bf16 v[56:59], v[20:23], v[104:107], v[56:59]
  v_mfma_f32_16x16x32_bf16 v[60:63], v[20:23], v[108:111], v[60:63]
  s_waitcnt lgkmcnt(4)
  v_mfma_f32_16x16x32_bf16 v[32:35], v[24:27], v[112:115], v[32:35]
  ds_read_b64_tr_b16 v[20:21], v5 offset:4096
  v_mfma_f32_16x16x32_bf16 v[36:39], v[24:27], v[116:119], v[36:39]
  ds_read_b64_tr_b16 v[22:23], v5 offset:6144
  v_mfma_f32_16x16x32_bf16 v[40:43], v[24:27], v[120:123], v[40:43]
  v_mfma_f32_16x16x32_bf16 v[44:47], v[24:27], v[124:127], v[44:47]
  s_waitcnt lgkmcnt(4)
  v_mfma_f32_16x16x32_bf16 v[48:51], v[28:31], v[112:115], v[48:51]
  ds_read_b64_tr_b16 v[24:25], v3 offset:8192
  v_mfma_f32_16x16x32_bf16 v[52:55], v[28:31], v[116:119], v[52:55]
  ds_read_b64_tr_b16 v[26:27], v3 offset:10240
  v_mfma_f32_16x16x32_bf16 v[56:59], v[28:31], v[120:123], v[56:59]
  v_mfma_f32_16x16x32_bf16 v[60:63], v[28:31], v[124:127], v[60:63]
  s_waitcnt lgkmcnt(4)
  v_mfma_f32_16x16x32_bf16 v[32:35], v[16:19], v[128:131], v[32:35]
  ds_read_b64_tr_b16 v[28:29], v5 offset:8192
  v_mfma_f32_16x16x32_bf16 v[36:39], v[16:19], v[132:135], v[36:39]
  ds_read_b64_tr_b16 v[30:31], v5 offset:10240
  v_mfma_f32_16x16x32_bf16 v[40:43], v[16:19], v[136:139], v[40:43]
  v_add_u32 v3, 0, v2
  v_mfma_f32_16x16x32_bf16 v[44:47], v[16:19], v[140:143], v[44:47]
  v_xor_b32 v5, 32, v3
  s_waitcnt lgkmcnt(4)
  v_mfma_f32_16x16x32_bf16 v[48:51], v[20:23], v[128:131], v[48:51]
  v_mfma_f32_16x16x32_bf16 v[52:55], v[20:23], v[132:135], v[52:55]
  v_mfma_f32_16x16x32_bf16 v[56:59], v[20:23], v[136:139], v[56:59]
  v_mfma_f32_16x16x32_bf16 v[60:63], v[20:23], v[140:143], v[60:63]
  s_waitcnt lgkmcnt(0)
  s_barrier
  v_mfma_f32_16x16x32_bf16 v[32:35], v[24:27], v[144:147], v[32:35]
  ds_read_b64_tr_b16 v[16:17], v3 offset:0
  v_mfma_f32_16x16x32_bf16 v[36:39], v[24:27], v[148:151], v[36:39]
  ds_read_b64_tr_b16 v[18:19], v3 offset:2048
  v_mfma_f32_16x16x32_bf16 v[40:43], v[24:27], v[152:155], v[40:43]
  ds_read_b64_tr_b16 v[20:21], v5 offset:0
  v_mfma_f32_16x16x32_bf16 v[44:47], v[24:27], v[156:159], v[44:47]
  ds_read_b64_tr_b16 v[22:23], v5 offset:2048
  v_mfma_f32_16x16x32_bf16 v[48:51], v[28:31], v[144:147], v[48:51]
  ds_read_b64_tr_b16 v[24:25], v3 offset:4096
  v_mfma_f32_16x16x32_bf16 v[52:55], v[28:31], v[148:151], v[52:55]
  ds_read_b64_tr_b16 v[26:27], v3 offset:6144
  v_mfma_f32_16x16x32_bf16 v[56:59], v[28:31], v[152:155], v[56:59]
  v_mfma_f32_16x16x32_bf16 v[60:63], v[28:31], v[156:159], v[60:63]
  s_waitcnt lgkmcnt(4)
  v_mfma_f32_16x16x32_bf16 v[32:35], v[16:19], v[160:163], v[32:35]
  ds_read_b64_tr_b16 v[28:29], v5 offset:4096
  v_mfma_f32_16x16x32_bf16 v[36:39], v[16:19], v[164:167], v[36:39]
  ds_read_b64_tr_b16 v[30:31], v5 offset:6144
  v_mfma_f32_16x16x32_bf16 v[40:43], v[16:19], v[168:171], v[40:43]
  v_mfma_f32_16x16x32_bf16 v[44:47], v[16:19], v[172:175], v[44:47]
  s_waitcnt lgkmcnt(4)
  v_mfma_f32_16x16x32_bf16 v[48:51], v[20:23], v[160:163], v[48:51]
  ds_read_b64_tr_b16 v[16:17], v3 offset:8192
  v_mfma_f32_16x16x32_bf16 v[52:55], v[20:23], v[164:167], v[52:55]
  ds_read_b64_tr_b16 v[18:19], v3 offset:10240
  v_mfma_f32_16x16x32_bf16 v[56:59], v[20:23], v[168:171], v[56:59]
  v_mfma_f32_16x16x32_bf16 v[60:63], v[20:23], v[172:175], v[60:63]
  s_waitcnt lgkmcnt(4)
  v_mfma_f32_16x16x32_bf16 v[32:35], v[24:27], v[176:179], v[32:35]
  ds_read_b64_tr_b16 v[20:21], v5 offset:8192
  v_mfma_f32_16x16x32_bf16 v[36:39], v[24:27], v[180:183], v[36:39]
  ds_read_b64_tr_b16 v[22:23], v5 offset:10240
  v_mfma_f32_16x16x32_bf16 v[40:43], v[24:27], v[184:187], v[40:43]
  v_add_u32 v3, 98304, v2
  v_mfma_f32_16x16x32_bf16 v[44:47], v[24:27], v[188:191], v[44:47]
  v_xor_b32 v5, 32, v3
  s_waitcnt lgkmcnt(4)
  v_mfma_f32_16x16x32_bf16 v[48:51], v[28:31], v[176:179], v[48:51]
  v_mfma_f32_16x16x32_bf16 v[52:55], v[28:31], v[180:183], v[52:55]
  v_mfma_f32_16x16x32_bf16 v[56:59], v[28:31], v[184:187], v[56:59]
  v_mfma_f32_16x16x32_bf16 v[60:63], v[28:31], v[188:191], v[60:63]
  s_waitcnt vmcnt(0) lgkmcnt(0)
  s_barrier
  v_mfma_f32_16x16x32_bf16 v[32:35], v[16:19], v[192:195], v[32:35]
  ds_read_b64_tr_b16 v[24:25], v3 offset:0
  v_mfma_f32_16x16x32_bf16 v[36:39], v[16:19], v[196:199], v[36:39]
  ds_read_b64_tr_b16 v[26:27], v3 offset:2048
  v_mfma_f32_16x16x32_bf16 v[40:43], v[16:19], v[200:203], v[40:43]
  ds_read_b64_tr_b16 v[28:29], v5 offset:0
  v_mfma_f32_16x16x32_bf16 v[44:47], v[16:19], v[204:207], v[44:47]
  ds_read_b64_tr_b16 v[30:31], v5 offset:2048
  v_mfma_f32_16x16x32_bf16 v[48:51], v[20:23], v[192:195], v[48:51]
  ds_read_b64_tr_b16 v[16:17], v3 offset:4096
  v_mfma_f32_16x16x32_bf16 v[52:55], v[20:23], v[196:199], v[52:55]
  ds_read_b64_tr_b16 v[18:19], v3 offset:6144
  v_mfma_f32_16x16x32_bf16 v[56:59], v[20:23], v[200:203], v[56:59]
  s_cmp_lg_u32 s28, 0
  s_cbranch_scc1 L_sig0
  v_mov_b32 v12, s80
  s_mov_b64 exec, 255
  buffer_store_dwordx4 v[12:15], v6, s[24:27], s85 offen offset:0 sc1
  s_mov_b64 exec, -1
L_sig0:
  v_mfma_f32_16x16x32_bf16 v[60:63], v[20:23], v[204:207], v[60:63]
  s_waitcnt lgkmcnt(4)
  v_mfma_f32_16x16x32_bf16 v[32:35], v[24:27], v[208:211], v[32:35]
  ds_read_b64_tr_b16 v[20:21], v5 offset:4096
  v_mfma_f32_16x16x32_bf16 v[36:39], v[24:27], v[212:215], v[36:39]
  ds_read_b64_tr_b16 v[22:23], v5 offset:6144
  v_mfma_f32_16x16x32_bf16 v[40:43], v[24:27], v[216:219], v[40:43]
  v_mfma_f32_16x16x32_bf16 v[44:47], v[24:27], v[220:223], v[44:47]
  s_waitcnt lgkmcnt(4)
  v_mfma_f32_16x16x32_bf16 v[48:51], v[28:31], v[208:211], v[48:51]
  ds_read_b64_tr_b16 v[24:25], v3 offset:8192
  v_mfma_f32_16x16x32_bf16 v[52:55], v[28:31], v[212:215], v[52:55]
  ds_read_b64_tr_b16 v[26:27], v3 offset:10240
  v_mfma_f32_16x16x32_bf16 v[56:59], v[28:31], v[216:219], v[56:59]
  v_mfma_f32_16x16x32_bf16 v[60:63], v[28:31], v[220:223], v[60:63]
  s_waitcnt lgkmcnt(4)
  v_mfma_f32_16x16x32_bf16 v[32:35], v[16:19], v[224:227], v[32:35]
  ds_read_b64_tr_b16 v[28:29], v5 offset:8192
  v_mfma_f32_16x16x32_bf16 v[36:39], v[16:19], v[228:231], v[36:39]
  ds_read_b64_tr_b16 v[30:31], v5 offset:10240
  v_mfma_f32_16x16x32_bf16 v[40:43], v[16:19], v[232:235], v[40:43]
  v_add_u32 v3, 122880, v2
  v_mfma_f32_16x16x32_bf16 v[44:47], v[16:19], v[236:239], v[44:47]
  v_xor_b32 v5, 32, v3
  s_waitcnt lgkmcnt(4)
  v_mfma_f32_16x16x32_bf16 v[48:51], v[20:23], v[224:227], v[48:51]
  v_mfma_f32_16x16x32_bf16 v[52:55], v[20:23], v[228:231], v[52:55]
  v_mfma_f32_16x16x32_bf16 v[56:59], v[20:23], v[232:235], v[56:59]
  v_mfma_f32_16x16x32_bf16 v[60:63], v[20:23], v[236:239], v[60:63]
  s_waitcnt lgkmcnt(0)
  s_barrier
  v_mfma_f32_16x16x32_bf16 v[32:35], v[24:27], v[240:243], v[32:35]
  ds_read_b64_tr_b16 v[16:17], v3 offset:0
  v_mfma_f32_16x16x32_bf16 v[36:39], v[24:27], v[244:247], v[36:39]
  ds_read_b64_tr_b16 v[18:19], v3 offset:2048
  v_mfma_f32_16x16x32_bf16 v[40:43], v[24:27], v[248:251], v[40:43]
  ds_read_b64_tr_b16 v[20:21], v5 offset:0
  v_mfma_f32_16x16x32_bf16 v[44:47], v[24:27], v[252:255], v[44:47]
  ds_read_b64_tr_b16 v[22:23], v5 offset:2048
  v_mfma_f32_16x16x32_bf16 v[48:51], v[28:31], v[240:243], v[48:51]
  ds_read_b64_tr_b16 v[24:25], v3 offset:4096
  v_mfma_f32_16x16x32_bf16 v[52:55], v[28:31], v[244:247], v[52:55]
  ds_read_b64_tr_b16 v[26:27], v3 offset:6144
  v_mfma_f32_16x16x32_bf16 v[56:59], v[28:31], v[248:251], v[56:59]
  v_mfma_f32_16x16x32_bf16 v[60:63], v[28:31], v[252:255], v[60:63]
  s_waitcnt lgkmcnt(4)
  v_cvt_pk_bf16_f32 v8, v32, v33
  v_cvt_pk_bf16_f32 v9, v34, v35
  v_mfma_f32_16x16x32_bf16 v[32:35], v[16:19], v[64:67], 0
  ds_read_b64_tr_b16 v[28:29], v5 offset:4096
  v_cvt_pk_bf16_f32 v10, v36, v37
  v_cvt_pk_bf16_f32 v11, v38, v39
  v_mfma_f32_16x16x32_bf16 v[36:39], v[16:19], v[68:71], 0
  buffer_store_dwordx4 v[8:11], v6, s[24:27], s46 offen offset:0 sc1
  ds_read_b64_tr_b16 v[30:31], v5 offset:6144
  v_cvt_pk_bf16_f32 v12, v40, v41
  v_cvt_pk_bf16_f32 v13, v42, v43
  v_mfma_f32_16x16x32_bf16 v[40:43], v[16:19], v[72:75], 0
  v_cvt_pk_bf16_f32 v14, v44, v45
  v_cvt_pk_bf16_f32 v15, v46, v47
  v_mfma_f32_16x16x32_bf16 v[44:47], v[16:19], v[76:79], 0
  buffer_store_dwordx4 v[12:15], v6, s[24:27], s46 offen offset:1024 sc1
  s_waitcnt lgkmcnt(4)
  v_cvt_pk_bf16_f32 v8, v48, v49
  v_cvt_pk_bf16_f32 v9, v50, v51
  v_mfma_f32_16x16x32_bf16 v[48:51], v[20:23], v[64:67], 0
  ds_read_b64_tr_b16 v[16:17], v3 offset:8192
  v_cvt_pk_bf16_f32 v10, v52, v53
  v_cvt_pk_bf16_f32 v11, v54, v55
  v_mfma_f32_16x16x32_bf16 v[52:55], v[20:23], v[68:71], 0
  buffer_store_dwordx4 v[8:11], v6, s[24:27], s46 offen offset:2048 sc1
  ds_read_b64_tr_b16 v[18:19], v3 offset:10240
  v_cvt_pk_bf16_f32 v12, v56, v57
  v_cvt_pk_bf16_f32 v13, v58, v59
  v_mfma_f32_16x16x32_bf16 v[56:59], v[20:23], v[72:75], 0
  v_cvt_pk_bf16_f32 v14, v60, v61
  v_cvt_pk_bf16_f32 v15, v62, v63
  v_mfma_f32_16x16x32_bf16 v[60:63], v[20:23], v[76:79], 0
  buffer_store_dwordx4 v[12:15], v6, s[24:27], s46 offen offset:3072 sc1
  s_add_u32 s46, s46, 28672
  s_waitcnt lgkmcnt(4)
  v_mfma_f32_16x16x32_bf16 v[32:35], v[24:27], v[80:83], v[32:35]
  ds_read_b64_tr_b16 v[20:21], v5 offset:8192
  v_mfma_f32_16x16x32_bf16 v[36:39], v[24:27], v[84:87], v[36:39]
  ds_read_b64_tr_b16 v[22:23], v5 offset:10240
  v_mfma_f32_16x16x32_bf16 v[40:43], v[24:27], v[88:91], v[40:43]
  v_add_u32 v3, 49152, v2
  v_mfma_f32_16x16x32_bf16 v[44:47], v[24:27], v[92:95], v[44:47]
  v_xor_b32 v5, 32, v3
  s_waitcnt lgkmcnt(4)
  v_mfma_f32_16x16x32_bf16 v[48:51], v[28:31], v[80:83], v[48:51]
  v_mfma_f32_16x16x32_bf16 v[52:55], v[28:31], v[84:87], v[52:55]
  v_mfma_f32_16x16x32_bf16 v[56:59], v[28:31], v[88:91], v[56:59]
  v_mfma_f32_16x16x32_bf16 v[60:63], v[28:31], v[92:95], v[60:63]
  s_waitcnt lgkmcnt(0)
  s_barrier
  v_mfma_f32_16x16x32_bf16 v[32:35], v[16:19], v[96:99], v[32:35]
  ds_read_b64_tr_b16 v[24:25], v3 offset:0
  v_mfma_f32_16x16x32_bf16 v[36:39], v[16:19], v[100:103], v[36:39]
  ds_read_b64_tr_b16 v[26:27], v3 offset:2048
  v_mfma_f32_16x16x32_bf16 v[40:43], v[16:19], v[104:107], v[40:43]
  ds_read_b64_tr_b16 v[28:29], v5 offset:0
  v_mfma_f32_16x16x32_bf16 v[44:47], v[16:19], v[108:111], v[44:47]
  ds_read_b64_tr_b16 v[30:31], v5 offset:2048
  v_mfma_f32_16x16x32_bf16 v[48:51], v[20:23], v[96:99], v[48:51]
  ds_read_b64_tr_b16 v[16:17], v3 offset:4096
  v_mfma_f32_16x16x32_bf16 v[52:55], v[20:23], v[100:103], v[52:55]
  ds_read_b64_tr_b16 v[18:19], v3 offset:6144
  v_mfma_f32_16x16x32_bf16 v[56:59], v[20:23], v[104:107], v[56:59]
  v_mfma_f32_16x16x32_bf16 v[60:63], v[20:23], v[108:111], v[60:63]
  s_waitcnt lgkmcnt(4)
  v_mfma_f32_16x16x32_bf16 v[32:35], v[24:27], v[112:115], v[32:35]
  ds_read_b64_tr_b16 v[20:21], v5 offset:4096
  v_mfma_f32_16x16x32_bf16 v[36:39], v[24:27], v[116:119], v[36:39]
  ds_read_b64_tr_b16 v[22:23], v5 offset:6144
  v_mfma_f32_16x16x32_bf16 v[40:43], v[24:27], v[120:123], v[40:43]
  v_mfma_f32_16x16x32_bf16 v[44:47], v[24:27], v[124:127], v[44:47]
  s_waitcnt lgkmcnt(4)
  v_mfma_f32_16x16x32_bf16 v[48:51], v[28:31], v[112:115], v[48:51]
  ds_read_b64_tr_b16 v[24:25], v3 offset:8192
  v_mfma_f32_16x16x32_bf16 v[52:55], v[28:31], v[116:119], v[52:55]
  ds_read_b64_tr_b16 v[26:27], v3 offset:10240
  v_mfma_f32_16x16x32_bf16 v[56:59], v[28:31], v[120:123], v[56:59]
  v_mfma_f32_16x16x32_bf16 v[60:63], v[28:31], v[124:127], v[60:63]
  s_waitcnt lgkmcnt(4)
  v_mfma_f32_16x16x32_bf16 v[32:35], v[16:19], v[128:131], v[32:35]
  ds_read_b64_tr_b16 v[28:29], v5 offset:8192
  v_mfma_f32_16x16x32_bf16 v[36:39], v[16:19], v[132:135], v[36:39]
  ds_read_b64_tr_b16 v[30:31], v5 offset:10240
  v_mfma_f32_16x16x32_bf16 v[40:43], v[16:19], v[136:139], v[40:43]
  v_add_u32 v3, 73728, v2
  v_mfma_f32_16x16x32_bf16 v[44:47], v[16:19], v[140:143], v[44:47]
  v_xor_b32 v5, 32, v3
  s_waitcnt lgkmcnt(4)
  v_mfma_f32_16x16x32_bf16 v[48:51], v[20:23], v[128:131], v[48:51]
  v_mfma_f32_16x16x32_bf16 v[52:55], v[20:23], v[132:135], v[52:55]
  v_mfma_f32_16x16x32_bf16 v[56:59], v[20:23], v[136:139], v[56:59]
  v_mfma_f32_16x16x32_bf16 v[60:63], v[20:23], v[140:143], v[60:63]
  s_waitcnt lgkmcnt(0)
  s_barrier
  v_mfma_f32_16x16x32_bf16 v[32:35], v[24:27], v[144:147], v[32:35]
  ds_read_b64_tr_b16 v[16:17], v3 offset:0
  v_mfma_f32_16x16x32_bf16 v[36:39], v[24:27], v[148:151], v[36:39]
  ds_read_b64_tr_b16 v[18:19], v3 offset:2048
  v_mfma_f32_16x16x32_bf16 v[40:43], v[24:27], v[152:155], v[40:43]
  ds_read_b64_tr_b16 v[20:21], v5 offset:0
  v_mfma_f32_16x16x32_bf16 v[44:47], v[24:27], v[156:159], v[44:47]
  ds_read_b64_tr_b16 v[22:23], v5 offset:2048
  v_mfma_f32_16x16x32_bf16 v[48:51], v[28:31], v[144:147], v[48:51]
  ds_read_b64_tr_b16 v[24:25], v3 offset:4096
  v_mfma_f32_16x16x32_bf16 v[52:55], v[28:31], v[148:151], v[52:55]
  ds_read_b64_tr_b16 v[26:27], v3 offset:6144
  v_mfma_f32_16x16x32_bf16 v[56:59], v[28:31], v[152:155], v[56:59]
  v_mfma_f32_16x16x32_bf16 v[60:63], v[28:31], v[156:159], v[60:63]
  s_waitcnt lgkmcnt(4)
  v_mfma_f32_16x16x32_bf16 v[32:35], v[16:19], v[160:163], v[32:35]
  ds_read_b64_tr_b16 v[28:29], v5 offset:4096
  v_mfma_f32_16x16x32_bf16 v[36:39], v[16:19], v[164:167], v[36:39]
  ds_read_b64_tr_b16 v[30:31], v5 offset:6144
  v_mfma_f32_16x16x32_bf16 v[40:43], v[16:19], v[168:171], v[40:43]
  v_mfma_f32_16x16x32_bf16 v[44:47], v[16:19], v[172:175], v[44:47]
  s_waitcnt lgkmcnt(4)
  v_mfma_f32_16x16x32_bf16 v[48:51], v[20:23], v[160:163], v[48:51]
  ds_read_b64_tr_b16 v[16:17], v3 offset:8192
  v_mfma_f32_16x16x32_bf16 v[52:55], v[20:23], v[164:167], v[52:55]
  ds_read_b64_tr_b16 v[18:19], v3 offset:10240
  v_mfma_f32_16x16x32_bf16 v[56:59], v[20:23], v[168:171], v[56:59]
  v_mfma_f32_16x16x32_bf16 v[60:63], v[20:23], v[172:175], v[60:63]
  s_waitcnt lgkmcnt(4)
  v_mfma_f32_16x16x32_bf16 v[32:35], v[24:27], v[176:179], v[32:35]
  ds_read_b64_tr_b16 v[20:21], v5 offset:8192
  v_mfma_f32_16x16x32_bf16 v[36:39], v[24:27], v[180:183], v[36:39]
  ds_read_b64_tr_b16 v[22:23], v5 offset:10240
  v_mfma_f32_16x16x32_bf16 v[40:43], v[24:27], v[184:187], v[40:43]
  v_add_u32 v3, 24576, v2
  v_mfma_f32_16x16x32_bf16 v[44:47], v[24:27], v[188:191], v[44:47]
  v_xor_b32 v5, 32, v3
  s_waitcnt lgkmcnt(4)
  v_mfma_f32_16x16x32_bf16 v[48:51], v[28:31], v[176:179], v[48:51]
  v_mfma_f32_16x16x32_bf16 v[52:55], v[28:31], v[180:183], v[52:55]
  v_mfma_f32_16x16x32_bf16 v[56:59], v[28:31], v[184:187], v[56:59]
  v_mfma_f32_16x16x32_bf16 v[60:63], v[28:31], v[188:191], v[60:63]
  s_waitcnt vmcnt(0) lgkmcnt(0)
  s_barrier
  v_mfma_f32_16x16x32_bf16 v[32:35], v[16:19], v[192:195], v[32:35]
  ds_read_b64_tr_b16 v[24:25], v3 offset:0
  v_mfma_f32_16x16x32_bf16 v[36:39], v[16:19], v[196:199], v[36:39]
  ds_read_b64_tr_b16 v[26:27], v3 offset:2048
  v_mfma_f32_16x16x32_bf16 v[40:43], v[16:19], v[200:203], v[40:43]
  ds_read_b64_tr_b16 v[28:29], v5 offset:0
  v_mfma_f32_16x16x32_bf16 v[44:47], v[16:19], v[204:207], v[44:47]
  ds_read_b64_tr_b16 v[30:31], v5 offset:2048
  v_mfma_f32_16x16x32_bf16 v[48:51], v[20:23], v[192:195], v[48:51]
  ds_read_b64_tr_b16 v[16:17], v3 offset:4096
  v_mfma_f32_16x16x32_bf16 v[52:55], v[20:23], v[196:199], v[52:55]
  ds_read_b64_tr_b16 v[18:19], v3 offset:6144
  v_mfma_f32_16x16x32_bf16 v[56:59], v[20:23], v[200:203], v[56:59]
  s_cmp_lg_u32 s28, 0
  s_cbranch_scc1 L_sig1
  v_mov_b32 v12, s80
  s_mov_b64 exec, 255
  buffer_store_dwordx4 v[12:15], v6, s[24:27], s85 offen offset:128 sc1
  s_mov_b64 exec, -1
L_sig1:
  v_mfma_f32_16x16x32_bf16 v[60:63], v[20:23], v[204:207], v[60:63]
  s_waitcnt lgkmcnt(4)
  v_mfma_f32_16x16x32_bf16 v[32:35], v[24:27], v[208:211], v[32:35]
  ds_read_b64_tr_b16 v[20:21], v5 offset:4096
  v_mfma_f32_16x16x32_bf16 v[36:39], v[24:27], v[212:215], v[36:39]
  ds_read_b64_tr_b16 v[22:23], v5 offset:6144
  v_mfma_f32_16x16x32_bf16 v[40:43], v[24:27], v[216:219], v[40:43]
  v_mfma_f32_16x16x32_bf16 v[44:47], v[24:27], v[220:223], v[44:47]
  s_waitcnt lgkmcnt(4)
  v_mfma_f32_16x16x32_bf16 v[48:51], v[28:31], v[208:211], v[48:51]
  ds_read_b64_tr_b16 v[24:25], v3 offset:8192
  v_mfma_f32_16x16x32_bf16 v[52:55], v[28:31], v[212:215], v[52:55]
  ds_read_b64_tr_b16 v[26:27], v3 offset:10240
  v_mfma_f32_16x16x32_bf16 v[56:59], v[28:31], v[216:219], v[56:59]
  v_mfma_f32_16x16x32_bf16 v[60:63], v[28:31], v[220:223], v[60:63]
  s_waitcnt lgkmcnt(4)
  v_mfma_f32_16x16x32_bf16 v[32:35], v[16:19], v[224:227], v[32:35]
  ds_read_b64_tr_b16 v[28:29], v5 offset:8192
  v_mfma_f32_16x16x32_bf16 v[36:39], v[16:19], v[228:231], v[36:39]
  ds_read_b64_tr_b16 v[30:31], v5 offset:10240
  v_mfma_f32_16x16x32_bf16 v[40:43], v[16:19], v[232:235], v[40:43]
  v_add_u32 v3, 0, v2
  v_mfma_f32_16x16x32_bf16 v[44:47], v[16:19], v[236:239], v[44:47]
  v_xor_b32 v5, 32, v3
  s_waitcnt lgkmcnt(4)
  v_mfma_f32_16x16x32_bf16 v[48:51], v[20:23], v[224:227], v[48:51]
  v_mfma_f32_16x16x32_bf16 v[52:55], v[20:23], v[228:231], v[52:55]
  v_mfma_f32_16x16x32_bf16 v[56:59], v[20:23], v[232:235], v[56:59]
  v_mfma_f32_16x16x32_bf16 v[60:63], v[20:23], v[236:239], v[60:63]
  s_waitcnt lgkmcnt(0)
  s_barrier
  v_mfma_f32_16x16x32_bf16 v[32:35], v[24:27], v[240:243], v[32:35]
  ds_read_b64_tr_b16 v[16:17], v3 offset:0
  v_mfma_f32_16x16x32_bf16 v[36:39], v[24:27], v[244:247], v[36:39]
  ds_read_b64_tr_b16 v[18:19], v3 offset:2048
  v_mfma_f32_16x16x32_bf16 v[40:43], v[24:27], v[248:251], v[40:43]
  ds_read_b64_tr_b16 v[20:21], v5 offset:0
  v_mfma_f32_16x16x32_bf16 v[44:47], v[24:27], v[252:255], v[44:47]
  ds_read_b64_tr_b16 v[22:23], v5 offset:2048
  v_mfma_f32_16x16x32_bf16 v[48:51], v[28:31], v[240:243], v[48:51]
  ds_read_b64_tr_b16 v[24:25], v3 offset:4096
  v_mfma_f32_16x16x32_bf16 v[52:55], v[28:31], v[244:247], v[52:55]
  ds_read_b64_tr_b16 v[26:27], v3 offset:6144
  v_mfma_f32_16x16x32_bf16 v[56:59], v[28:31], v[248:251], v[56:59]
  v_mfma_f32_16x16x32_bf16 v[60:63], v[28:31], v[252:255], v[60:63]
  s_waitcnt lgkmcnt(4)
  v_cvt_pk_bf16_f32 v8, v32, v33
  v_cvt_pk_bf16_f32 v9, v34, v35
  v_mfma_f32_16x16x32_bf16 v[32:35], v[16:19], v[64:67], 0
  ds_read_b64_tr_b16 v[28:29], v5 offset:4096
  v_cvt_pk_bf16_f32 v10, v36, v37
  v_cvt_pk_bf16_f32 v11, v38, v39
  v_mfma_f32_16x16x32_bf16 v[36:39], v[16:19], v[68:71], 0
  buffer_store_dwordx4 v[8:11], v6, s[24:27], s46 offen offset:0 sc1
  ds_read_b64_tr_b16 v[30:31], v5 offset:6144
  v_cvt_pk_bf16_f32 v12, v40, v41
  v_cvt_pk_bf16_f32 v13, v42, v43
  v_mfma_f32_16x16x32_bf16 v[40:43], v[16:19], v[72:75], 0
  v_cvt_pk_bf16_f32 v14, v44, v45
  v_cvt_pk_bf16_f32 v15, v46, v47
  v_mfma_f32_16x16x32_bf16 v[44:47], v[16:19], v[76:79], 0
  buffer_store_dwordx4 v[12:15], v6, s[24:27], s46 offen offset:1024 sc1
  s_waitcnt lgkmcnt(4)
  v_cvt_pk_bf16_f32 v8, v48, v49
  v_cvt_pk_bf16_f32 v9, v50, v51
  v_mfma_f32_16x16x32_bf16 v[48:51], v[20:23], v[64:67], 0
  ds_read_b64_tr_b16 v[16:17], v3 offset:8192
  v_cvt_pk_bf16_f32 v10, v52, v53
  v_cvt_pk_bf16_f32 v11, v54, v55
  v_mfma_f32_16x16x32_bf16 v[52:55], v[20:23], v[68:71], 0
  buffer_store_dwordx4 v[8:11], v6, s[24:27], s46 offen offset:2048 sc1
  ds_read_b64_tr_b16 v[18:19], v3 offset:10240
  v_cvt_pk_bf16_f32 v12, v56, v57
  v_cvt_pk_bf16_f32 v13, v58, v59
  v_mfma_f32_16x16x32_bf16 v[56:59], v[20:23], v[72:75], 0
  v_cvt_pk_bf16_f32 v14, v60, v61
  v_cvt_pk_bf16_f32 v15, v62, v63
  v_mfma_f32_16x16x32_bf16 v[60:63], v[20:23], v[76:79], 0
  buffer_store_dwordx4 v[12:15], v6, s[24:27], s46 offen offset:3072 sc1
  s_add_u32 s46, s46, 28672
  s_waitcnt lgkmcnt(4)
  v_mfma_f32_16x16x32_bf16 v[32:35], v[24:27], v[80:83], v[32:35]
  ds_read_b64_tr_b16 v[20:21], v5 offset:8192
  v_mfma_f32_16x16x32_bf16 v[36:39], v[24:27], v[84:87], v[36:39]
  ds_read_b64_tr_b16 v[22:23], v5 offset:10240
  v_mfma_f32_16x16x32_bf16 v[40:43], v[24:27], v[88:91], v[40:43]
  v_add_u32 v3, 98304, v2
  v_mfma_f32_16x16x32_bf16 v[44:47], v[24:27], v[92:95], v[44:47]
  v_xor_b32 v5, 32, v3
  s_waitcnt lgkmcnt(4)
  v_mfma_f32_16x16x32_bf16 v[48:51], v[28:31], v[80:83], v[48:51]
  v_mfma_f32_16x16x32_bf16 v[52:55], v[28:31], v[84:87], v[52:55]
  v_mfma_f32_16x16x32_bf16 v[56:59], v[28:31], v[88:91], v[56:59]
  v_mfma_f32_16x16x32_bf16 v[60:63], v[28:31], v[92:95], v[60:63]
  s_waitcnt lgkmcnt(0)
  s_barrier
  v_mfma_f32_16x16x32_bf16 v[32:35], v[16:19], v[96:99], v[32:35]
  ds_read_b64_tr_b16 v[24:25], v3 offset:0
  v_mfma_f32_16x16x32_bf16 v[36:39], v[16:19], v[100:103], v[36:39]
  ds_read_b64_tr_b16 v[26:27], v3 offset:2048
  v_mfma_f32_16x16x32_bf16 v[40:43], v[16:19], v[104:107], v[40:43]
  ds_read_b64_tr_b16 v[28:29], v5 offset:0
  v_mfma_f32_16x16x32_bf16 v[44:47], v[16:19], v[108:111], v[44:47]
  ds_read_b64_tr_b16 v[30:31], v5 offset:2048
  v_mfma_f32_16x16x32_bf16 v[48:51], v[20:23], v[96:99], v[48:51]
  ds_read_b64_tr_b16 v[16:17], v3 offset:4096
  v_mfma_f32_16x16x32_bf16 v[52:55], v[20:23], v[100:103], v[52:55]
  ds_read_b64_tr_b16 v[18:19], v3 offset:6144
  v_mfma_f32_16x16x32_bf16 v[56:59], v[20:23], v[104:107], v[56:59]
  v_mfma_f32_16x16x32_bf16 v[60:63], v[20:23], v[108:111], v[60:63]
  s_waitcnt lgkmcnt(4)
  v_mfma_f32_16x16x32_bf16 v[32:35], v[24:27], v[112:115], v[32:35]
  ds_read_b64_tr_b16 v[20:21], v5 offset:4096
  v_mfma_f32_16x16x32_bf16 v[36:39], v[24:27], v[116:119], v[36:39]
  ds_read_b64_tr_b16 v[22:23], v5 offset:6144
  v_mfma_f32_16x16x32_bf16 v[40:43], v[24:27], v[120:123], v[40:43]
  v_mfma_f32_16x16x32_bf16 v[44:47], v[24:27], v[124:127], v[44:47]
  s_waitcnt lgkmcnt(4)
  v_mfma_f32_16x16x32_bf16 v[48:51], v[28:31], v[112:115], v[48:51]
  ds_read_b64_tr_b16 v[24:25], v3 offset:8192
  v_mfma_f32_16x16x32_bf16 v[52:55], v[28:31], v[116:119], v[52:55]
  ds_read_b64_tr_b16 v[26:27], v3 offset:10240
  v_mfma_f32_16x16x32_bf16 v[56:59], v[28:31], v[120:123], v[56:59]
  v_mfma_f32_16x16x32_bf16 v[60:63], v[28:31], v[124:127], v[60:63]
  s_waitcnt lgkmcnt(4)
  v_mfma_f32_16x16x32_bf16 v[32:35], v[16:19], v[128:131], v[32:35]
  ds_read_b64_tr_b16 v[28:29], v5 offset:8192
  v_mfma_f32_16x16x32_bf16 v[36:39], v[16:19], v[132:135], v[36:39]
  ds_read_b64_tr_b16 v[30:31], v5 offset:10240
  v_mfma_f32_16x16x32_bf16 v[40:43], v[16:19], v[136:139], v[40:43]
  v_add_u32 v3, 122880, v2
  v_mfma_f32_16x16x32_bf16 v[44:47], v[16:19], v[140:143], v[44:47]
  v_xor_b32 v5, 32, v3
  s_waitcnt lgkmcnt(4)
  v_mfma_f32_16x16x32_bf16 v[48:51], v[20:23], v[128:131], v[48:51]
  v_mfma_f32_16x16x32_bf16 v[52:55], v[20:23], v[132:135], v[52:55]
  v_mfma_f32_16x16x32_bf16 v[56:59], v[20:23], v[136:139], v[56:59]
  v_mfma_f32_16x16x32_bf16 v[60:63], v[20:23], v[140:143], v[60:63]
  s_waitcnt lgkmcnt(0)
  s_barrier
  v_mfma_f32_16x16x32_bf16 v[32:35], v[24:27], v[144:147], v[32:35]
  ds_read_b64_tr_b16 v[16:17], v3 offset:0
  v_mfma_f32_16x16x32_bf16 v[36:39], v[24:27], v[148:151], v[36:39]
  ds_read_b64_tr_b16 v[18:19], v3 offset:2048
  v_mfma_f32_16x16x32_bf16 v[40:43], v[24:27], v[152:155], v[40:43]
  ds_read_b64_tr_b16 v[20:21], v5 offset:0
  v_mfma_f32_16x16x32_bf16 v[44:47], v[24:27], v[156:159], v[44:47]
  ds_read_b64_tr_b16 v[22:23], v5 offset:2048
  v_mfma_f32_16x16x32_bf16 v[48:51], v[28:31], v[144:147], v[48:51]
  ds_read_b64_tr_b16 v[24:25], v3 offset:4096
  v_mfma_f32_16x16x32_bf16 v[52:55], v[28:31], v[148:151], v[52:55]
  ds_read_b64_tr_b16 v[26:27], v3 offset:6144
  v_mfma_f32_16x16x32_bf16 v[56:59], v[28:31], v[152:155], v[56:59]
  v_mfma_f32_16x16x32_bf16 v[60:63], v[28:31], v[156:159], v[60:63]
  s_waitcnt lgkmcnt(4)
  v_mfma_f32_16x16x32_bf16 v[32:35], v[16:19], v[160:163], v[32:35]
  ds_read_b64_tr_b16 v[28:29], v5 offset:4096
  v_mfma_f32_16x16x32_bf16 v[36:39], v[16:19], v[164:167], v[36:39]
  ds_read_b64_tr_b16 v[30:31], v5 offset:6144
  v_mfma_f32_16x16x32_bf16 v[40:43], v[16:19], v[168:171], v[40:43]
  v_mfma_f32_16x16x32_bf16 v[44:47], v[16:19], v[172:175], v[44:47]
  s_waitcnt lgkmcnt(4)
  v_mfma_f32_16x16x32_bf16 v[48:51], v[20:23], v[160:163], v[48:51]
  ds_read_b64_tr_b16 v[16:17], v3 offset:8192
  v_mfma_f32_16x16x32_bf16 v[52:55], v[20:23], v[164:167], v[52:55]
  ds_read_b64_tr_b16 v[18:19], v3 offset:10240
  v_mfma_f32_16x16x32_bf16 v[56:59], v[20:23], v[168:171], v[56:59]
  v_mfma_f32_16x16x32_bf16 v[60:63], v[20:23], v[172:175], v[60:63]
  s_waitcnt lgkmcnt(4)
  v_mfma_f32_16x16x32_bf16 v[32:35], v[24:27], v[176:179], v[32:35]
  ds_read_b64_tr_b16 v[20:21], v5 offset:8192
  v_mfma_f32_16x16x32_bf16 v[36:39], v[24:27], v[180:183], v[36:39]
  ds_read_b64_tr_b16 v[22:23], v5 offset:10240
  v_mfma_f32_16x16x32_bf16 v[40:43], v[24:27], v[184:187], v[40:43]
  v_add_u32 v3, 49152, v2
  v_mfma_f32_16x16x32_bf16 v[44:47], v[24:27], v[188:191], v[44:47]
  v_xor_b32 v5, 32, v3
  s_waitcnt lgkmcnt(4)
  v_mfma_f32_16x16x32_bf16 v[48:51], v[28:31], v[176:179], v[48:51]
  v_mfma_f32_16x16x32_bf16 v[52:55], v[28:31], v[180:183], v[52:55]
  v_mfma_f32_16x16x32_bf16 v[56:59], v[28:31], v[184:187], v[56:59]
  v_mfma_f32_16x16x32_bf16 v[60:63], v[28:31], v[188:191], v[60:63]
  s_waitcnt vmcnt(0) lgkmcnt(0)
  s_barrier
  v_mfma_f32_16x16x32_bf16 v[32:35], v[16:19], v[192:195], v[32:35]
  ds_read_b64_tr_b16 v[24:25], v3 offset:0
  v_mfma_f32_16x16x32_bf16 v[36:39], v[16:19], v[196:199], v[36:39]
  ds_read_b64_tr_b16 v[26:27], v3 offset:2048
  v_mfma_f32_16x16x32_bf16 v[40:43], v[16:19], v[200:203], v[40:43]
  ds_read_b64_tr_b16 v[28:29], v5 offset:0
  v_mfma_f32_16x16x32_bf16 v[44:47], v[16:19], v[204:207], v[44:47]
  ds_read_b64_tr_b16 v[30:31], v5 offset:2048
  v_mfma_f32_16x16x32_bf16 v[48:51], v[20:23], v[192:195], v[48:51]
  ds_read_b64_tr_b16 v[16:17], v3 offset:4096
  v_mfma_f32_16x16x32_bf16 v[52:55], v[20:23], v[196:199], v[52:55]
  ds_read_b64_tr_b16 v[18:19], v3 offset:6144
  v_mfma_f32_16x16x32_bf16 v[56:59], v[20:23], v[200:203], v[56:59]
  s_cmp_lg_u32 s28, 0
  s_cbranch_scc1 L_sig2
  v_mov_b32 v12, s80
  s_mov_b64 exec, 255
  buffer_store_dwordx4 v[12:15], v6, s[24:27], s85 offen offset:256 sc1
  s_mov_b64 exec, -1
L_sig2:
  v_mfma_f32_16x16x32_bf16 v[60:63], v[20:23], v[204:207], v[60:63]
  s_waitcnt lgkmcnt(4)
  v_mfma_f32_16x16x32_bf16 v[32:35], v[24:27], v[208:211], v[32:35]
  ds_read_b64_tr_b16 v[20:21], v5 offset:4096
  v_mfma_f32_16x16x32_bf16 v[36:39], v[24:27], v[212:215], v[36:39]
  ds_read_b64_tr_b16 v[22:23], v5 offset:6144
  v_mfma_f32_16x16x32_bf16 v[40:43], v[24:27], v[216:219], v[40:43]
  v_mfma_f32_16x16x32_bf16 v[44:47], v[24:27], v[220:223], v[44:47]
  s_waitcnt lgkmcnt(4)
  v_mfma_f32_16x16x32_bf16 v[48:51], v[28:31], v[208:211], v[48:51]
  ds_read_b64_tr_b16 v[24:25], v3 offset:8192
  v_mfma_f32_16x16x32_bf16 v[52:55], v[28:31], v[212:215], v[52:55]
  ds_read_b64_tr_b16 v[26:27], v3 offset:10240
  v_mfma_f32_16x16x32_bf16 v[56:59], v[28:31], v[216:219], v[56:59]
  v_mfma_f32_16x16x32_bf16 v[60:63], v[28:31], v[220:223], v[60:63]
  s_waitcnt lgkmcnt(4)
  v_mfma_f32_16x16x32_bf16 v[32:35], v[16:19], v[224:227], v[32:35]
  ds_read_b64_tr_b16 v[28:29], v5 offset:8192
  v_mfma_f32_16x16x32_bf16 v[36:39], v[16:19], v[228:231], v[36:39]
  ds_read_b64_tr_b16 v[30:31], v5 offset:10240
  v_mfma_f32_16x16x32_bf16 v[40:43], v[16:19], v[232:235], v[40:43]
  v_add_u32 v3, 73728, v2
  v_mfma_f32_16x16x32_bf16 v[44:47], v[16:19], v[236:239], v[44:47]
  v_xor_b32 v5, 32, v3
  s_waitcnt lgkmcnt(4)
  v_mfma_f32_16x16x32_bf16 v[48:51], v[20:23], v[224:227], v[48:51]
  v_bfe_u32 v7, v0, 3, 4
  v_mul_lo_u32 v7, v7, s90
  buffer_load_dword v4, v7, s[24:27], s83 offen sc1
  v_mfma_f32_16x16x32_bf16 v[52:55], v[20:23], v[228:231], v[52:55]
  v_mfma_f32_16x16x32_bf16 v[56:59], v[20:23], v[232:235], v[56:59]
  v_mfma_f32_16x16x32_bf16 v[60:63], v[20:23], v[236:239], v[60:63]
  s_waitcnt lgkmcnt(0)
  s_barrier
  v_mfma_f32_16x16x32_bf16 v[32:35], v[24:27], v[240:243], v[32:35]
  ds_read_b64_tr_b16 v[16:17], v3 offset:0
  v_mfma_f32_16x16x32_bf16 v[36:39], v[24:27], v[244:247], v[36:39]
  ds_read_b64_tr_b16 v[18:19], v3 offset:2048
  v_mfma_f32_16x16x32_bf16 v[40:43], v[24:27], v[248:251], v[40:43]
  ds_read_b64_tr_b16 v[20:21], v5 offset:0
  v_mfma_f32_16x16x32_bf16 v[44:47], v[24:27], v[252:255], v[44:47]
  ds_read_b64_tr_b16 v[22:23], v5 offset:2048
  v_mfma_f32_16x16x32_bf16 v[48:51], v[28:31], v[240:243], v[48:51]
  ds_read_b64_tr_b16 v[24:25], v3 offset:4096
  v_mfma_f32_16x16x32_bf16 v[52:55], v[28:31], v[244:247], v[52:55]
  ds_read_b64_tr_b16 v[26:27], v3 offset:6144
  v_mfma_f32_16x16x32_bf16 v[56:59], v[28:31], v[248:251], v[56:59]
  v_mfma_f32_16x16x32_bf16 v[60:63], v[28:31], v[252:255], v[60:63]
  s_waitcnt lgkmcnt(4)
  v_cvt_pk_bf16_f32 v8, v32, v33
  v_cvt_pk_bf16_f32 v9, v34, v35
  v_mfma_f32_16x16x32_bf16 v[32:35], v[16:19], v[64:67], 0
  ds_read_b64_tr_b16 v[28:29], v5 offset:4096
  v_cvt_pk_bf16_f32 v10, v36, v37
  v_cvt_pk_bf16_f32 v11, v38, v39
  v_mfma_f32_16x16x32_bf16 v[36:39], v[16:19], v[68:71], 0
  buffer_store_dwordx4 v[8:11], v6, s[24:27], s46 offen offset:0 sc1
  ds_read_b64_tr_b16 v[30:31], v5 offset:6144
  v_cvt_pk_bf16_f32 v12, v40, v41
  v_cvt_pk_bf16_f32 v13, v42, v43
  v_mfma_f32_16x16x32_bf16 v[40:43], v[16:19], v[72:75], 0
  v_cvt_pk_bf16_f32 v14, v44, v45
  v_cvt_pk_bf16_f32 v15, v46, v47
  v_mfma_f32_16x16x32_bf16 v[44:47], v[16:19], v[76:79], 0
  buffer_store_dwordx4 v[12:15], v6, s[24:27], s46 offen offset:1024 sc1
  s_waitcnt lgkmcnt(4)
  v_cvt_pk_bf16_f32 v8, v48, v49
  v_cvt_pk_bf16_f32 v9, v50, v51
  v_mfma_f32_16x16x32_bf16 v[48:51], v[20:23], v[64:67], 0
  ds_read_b64_tr_b16 v[16:17], v3 offset:8192
  v_cvt_pk_bf16_f32 v10, v52, v53
  v_cvt_pk_bf16_f32 v11, v54, v55
  v_mfma_f32_16x16x32_bf16 v[52:55], v[20:23], v[68:71], 0
  buffer_store_dwordx4 v[8:11], v6, s[24:27], s46 offen offset:2048 sc1
  ds_read_b64_tr_b16 v[18:19], v3 offset:10240
  v_cvt_pk_bf16_f32 v12, v56, v57
  v_cvt_pk_bf16_f32 v13, v58, v59
  v_mfma_f32_16x16x32_bf16 v[56:59], v[20:23], v[72:75], 0
  v_cvt_pk_bf16_f32 v14, v60, v61
  v_cvt_pk_bf16_f32 v15, v62, v63
  v_mfma_f32_16x16x32_bf16 v[60:63], v[20:23], v[76:79], 0
  buffer_store_dwordx4 v[12:15], v6, s[24:27], s46 offen offset:3072 sc1
  s_add_u32 s46, s46, 28672
  s_waitcnt lgkmcnt(4)
  v_mfma_f32_16x16x32_bf16 v[32:35], v[24:27], v[80:83], v[32:35]
  ds_read_b64_tr_b16 v[20:21], v5 offset:8192
  v_mfma_f32_16x16x32_bf16 v[36:39], v[24:27], v[84:87], v[36:39]
  ds_read_b64_tr_b16 v[22:23], v5 offset:10240
  v_mfma_f32_16x16x32_bf16 v[40:43], v[24:27], v[88:91], v[40:43]
  v_add_u32 v3, 24576, v2
  v_mfma_f32_16x16x32_bf16 v[44:47], v[24:27], v[92:95], v[44:47]
  v_xor_b32 v5, 32, v3
  s_waitcnt lgkmcnt(4)
  v_mfma_f32_16x16x32_bf16 v[48:51], v[28:31], v[80:83], v[48:51]
  v_mfma_f32_16x16x32_bf16 v[52:55], v[28:31], v[84:87], v[52:55]
  v_mfma_f32_16x16x32_bf16 v[56:59], v[28:31], v[88:91], v[56:59]
  v_mfma_f32_16x16x32_bf16 v[60:63], v[28:31], v[92:95], v[60:63]
  s_waitcnt vmcnt(4) lgkmcnt(0)
  s_barrier
  v_mfma_f32_16x16x32_bf16 v[32:35], v[16:19], v[96:99], v[32:35]
  ds_read_b64_tr_b16 v[24:25], v3 offset:0
  v_mfma_f32_16x16x32_bf16 v[36:39], v[16:19], v[100:103], v[36:39]
  ds_read_b64_tr_b16 v[26:27], v3 offset:2048
  v_mfma_f32_16x16x32_bf16 v[40:43], v[16:19], v[104:107], v[40:43]
  ds_read_b64_tr_b16 v[28:29], v5 offset:0
  v_mfma_f32_16x16x32_bf16 v[44:47], v[16:19], v[108:111], v[44:47]
  ds_read_b64_tr_b16 v[30:31], v5 offset:2048
  v_mfma_f32_16x16x32_bf16 v[48:51], v[20:23], v[96:99], v[48:51]
  ds_read_b64_tr_b16 v[16:17], v3 offset:4096
  v_mfma_f32_16x16x32_bf16 v[52:55], v[20:23], v[100:103], v[52:55]
  ds_read_b64_tr_b16 v[18:19], v3 offset:6144
  v_mfma_f32_16x16x32_bf16 v[56:59], v[20:23], v[104:107], v[56:59]
  v_cmp_ne_u32 vcc, s80, v4
  v_mfma_f32_16x16x32_bf16 v[60:63], v[20:23], v[108:111], v[60:63]
  s_cmp_eq_u64 vcc, 0
  s_cselect_b32 s84, 2, 0
  s_cselect_b32 s47, 0, 0x40000000
  s_lshl_b32 s40, s91, 3
  s_sub_u32 s40, 512, s40
  v_add_u32 v7, s40, v0
  v_lshrrev_b32 v7, 9, v7
  v_lshl_or_b32 v7, v7, 30, v6
  v_or_b32 v7, s47, v7
  s_mov_b32 s45, s89
  s_waitcnt lgkmcnt(4)
  v_mfma_f32_16x16x32_bf16 v[32:35], v[24:27], v[112:115], v[32:35]
  ds_read_b64_tr_b16 v[20:21], v5 offset:4096
  v_mfma_f32_16x16x32_bf16 v[36:39], v[24:27], v[116:119], v[36:39]
  ds_read_b64_tr_b16 v[22:23], v5 offset:6144
  v_mfma_f32_16x16x32_bf16 v[40:43], v[24:27], v[120:123], v[40:43]
  buffer_load_dwordx4 v[64:67], v7, s[24:27], s45 offen sc1
  s_add_u32 s45, s45, 144000
  v_mfma_f32_16x16x32_bf16 v[44:47], v[24:27], v[124:127], v[44:47]
  buffer_load_dwordx4 v[68:71], v7, s[24:27], s45 offen sc1
  s_add_u32 s45, s45, 144000
  s_waitcnt lgkmcnt(4)
  v_mfma_f32_16x16x32_bf16 v[48:51], v[28:31], v[112:115], v[48:51]
  ds_read_b64_tr_b16 v[24:25], v3 offset:8192
  v_mfma_f32_16x16x32_bf16 v[52:55], v[28:31], v[116:119], v[52:55]
  ds_read_b64_tr_b16 v[26:27], v3 offset:10240
  v_mfma_f32_16x16x32_bf16 v[56:59], v[28:31], v[120:123], v[56:59]
  buffer_load_dwordx4 v[72:75], v7, s[24:27], s45 offen sc1
  s_add_u32 s45, s45, 144000
  v_mfma_f32_16x16x32_bf16 v[60:63], v[28:31], v[124:127], v[60:63]
  s_waitcnt lgkmcnt(4)
  v_mfma_f32_16x16x32_bf16 v[32:35], v[16:19], v[128:131], v[32:35]
  ds_read_b64_tr_b16 v[28:29], v5 offset:8192
  v_mfma_f32_16x16x32_bf16 v[36:39], v[16:19], v[132:135], v[36:39]
  ds_read_b64_tr_b16 v[30:31], v5 offset:10240
  v_mfma_f32_16x16x32_bf16 v[40:43], v[16:19], v[136:139], v[40:43]
  v_add_u32 v3, 0, v2
  v_mfma_f32_16x16x32_bf16 v[44:47], v[16:19], v[140:143], v[44:47]
  v_xor_b32 v5, 32, v3
  s_waitcnt lgkmcnt(4)
  v_mfma_f32_16x16x32_bf16 v[48:51], v[20:23], v[128:131], v[48:51]
  buffer_load_dwordx4 v[76:79], v7, s[24:27], s45 offen sc1
  s_add_u32 s45, s45, 144000
  v_mfma_f32_16x16x32_bf16 v[52:55], v[20:23], v[132:135], v[52:55]
  buffer_load_dwordx4 v[80:83], v7, s[24:27], s45 offen sc1
  s_add_u32 s45, s45, 144000
  v_mfma_f32_16x16x32_bf16 v[56:59], v[20:23], v[136:139], v[56:59]
  v_mfma_f32_16x16x32_bf16 v[60:63], v[20:23], v[140:143], v[60:63]
  s_waitcnt lgkmcnt(0)
  s_barrier
  v_mfma_f32_16x16x32_bf16 v[32:35], v[24:27], v[144:147], v[32:35]
  ds_read_b64_tr_b16 v[16:17], v3 offset:0
  v_mfma_f32_16x16x32_bf16 v[36:39], v[24:27], v[148:151], v[36:39]
  ds_read_b64_tr_b16 v[18:19], v3 offset:2048
  v_mfma_f32_16x16x32_bf16 v[40:43], v[24:27], v[152:155], v[40:43]
  ds_read_b64_tr_b16 v[20:21], v5 offset:0
  v_mfma_f32_16x16x32_bf16 v[44:47], v[24:27], v[156:159], v[44:47]
  ds_read_b64_tr_b16 v[22:23], v5 offset:2048
  v_mfma_f32_16x16x32_bf16 v[48:51], v[28:31], v[144:147], v[48:51]
  ds_read_b64_tr_b16 v[24:25], v3 offset:4096
  v_mfma_f32_16x16x32_bf16 v[52:55], v[28:31], v[148:151], v[52:55]
  ds_read_b64_tr_b16 v[26:27], v3 offset:6144
  v_mfma_f32_16x16x32_bf16 v[56:59], v[28:31], v[152:155], v[56:59]
  buffer_load_dwordx4 v[84:87], v7, s[24:27], s45 offen sc1
  s_add_u32 s45, s45, 144000
  v_mfma_f32_16x16x32_bf16 v[60:63], v[28:31], v[156:159], v[60:63]
  buffer_load_dwordx4 v[88:91], v7, s[24:27], s45 offen sc1
  s_add_u32 s45, s45, 144000
  s_waitcnt lgkmcnt(4)
  v_mfma_f32_16x16x32_bf16 v[32:35], v[16:19], v[160:163], v[32:35]
  ds_read_b64_tr_b16 v[28:29], v5 offset:4096
  v_mfma_f32_16x16x32_bf16 v[36:39], v[16:19], v[164:167], v[36:39]
  ds_read_b64_tr_b16 v[30:31], v5 offset:6144
  v_mfma_f32_16x16x32_bf16 v[40:43], v[16:19], v[168:171], v[40:43]
  buffer_load_dwordx4 v[92:95], v7, s[24:27], s45 offen sc1
  s_add_u32 s45, s45, 144000
  v_mfma_f32_16x16x32_bf16 v[44:47], v[16:19], v[172:175], v[44:47]
  s_waitcnt lgkmcnt(4)
  v_mfma_f32_16x16x32_bf16 v[48:51], v[20:23], v[160:163], v[48:51]
  ds_read_b64_tr_b16 v[16:17], v3 offset:8192
  v_mfma_f32_16x16x32_bf16 v[52:55], v[20:23], v[164:167], v[52:55]
  ds_read_b64_tr_b16 v[18:19], v3 offset:10240
  v_mfma_f32_16x16x32_bf16 v[56:59], v[20:23], v[168:171], v[56:59]
  buffer_load_dwordx4 v[96:99], v7, s[24:27], s45 offen sc1
  s_add_u32 s45, s45, 144000
  v_mfma_f32_16x16x32_bf16 v[60:63], v[20:23], v[172:175], v[60:63]
  s_waitcnt lgkmcnt(4)
  v_mfma_f32_16x16x32_bf16 v[32:35], v[24:27], v[176:179], v[32:35]
  ds_read_b64_tr_b16 v[20:21], v5 offset:8192
  v_mfma_f32_16x16x32_bf16 v[36:39], v[24:27], v[180:183], v[36:39]
  ds_read_b64_tr_b16 v[22:23], v5 offset:10240
  v_mfma_f32_16x16x32_bf16 v[40:43], v[24:27], v[184:187], v[40:43]
  v_add_u32 v3, 98304, v2
  v_mfma_f32_16x16x32_bf16 v[44:47], v[24:27], v[188:191], v[44:47]
  v_xor_b32 v5, 32, v3
  s_waitcnt lgkmcnt(4)
  v_mfma_f32_16x16x32_bf16 v[48:51], v[28:31], v[176:179], v[48:51]
  buffer_load_dwordx4 v[100:103], v7, s[24:27], s45 offen sc1
  s_add_u32 s45, s45, 144000
  v_mfma_f32_16x16x32_bf16 v[52:55], v[28:31], v[180:183], v[52:55]
  buffer_load_dwordx4 v[104:107], v7, s[24:27], s45 offen sc1
  s_add_u32 s45, s45, 144000
  v_mfma_f32_16x16x32_bf16 v[56:59], v[28:31], v[184:187], v[56:59]
  v_mfma_f32_16x16x32_bf16 v[60:63], v[28:31], v[188:191], v[60:63]
  s_waitcnt vmcnt(11) lgkmcnt(0)
  s_barrier
  v_mfma_f32_16x16x32_bf16 v[32:35], v[16:19], v[192:195], v[32:35]
  ds_read_b64_tr_b16 v[24:25], v3 offset:0
  v_mfma_f32_16x16x32_bf16 v[36:39], v[16:19], v[196:199], v[36:39]
  ds_read_b64_tr_b16 v[26:27], v3 offset:2048
  v_mfma_f32_16x16x32_bf16 v[40:43], v[16:19], v[200:203], v[40:43]
  ds_read_b64_tr_b16 v[28:29], v5 offset:0
  v_mfma_f32_16x16x32_bf16 v[44:47], v[16:19], v[204:207], v[44:47]
  ds_read_b64_tr_b16 v[30:31], v5 offset:2048
  v_mfma_f32_16x16x32_bf16 v[48:51], v[20:23], v[192:195], v[48:51]
  ds_read_b64_tr_b16 v[16:17], v3 offset:4096
  v_mfma_f32_16x16x32_bf16 v[52:55], v[20:23], v[196:199], v[52:55]
  ds_read_b64_tr_b16 v[18:19], v3 offset:6144
  v_mfma_f32_16x16x32_bf16 v[56:59], v[20:23], v[200:203], v[56:59]
  s_cmp_lg_u32 s28, 0
  s_cbranch_scc1 L_sig3
  v_mov_b32 v12, s80
  s_mov_b64 exec, 255
  buffer_store_dwordx4 v[12:15], v6, s[24:27], s85 offen offset:384 sc1
  s_mov_b64 exec, -1
L_sig3:
  v_mfma_f32_16x16x32_bf16 v[60:63], v[20:23], v[204:207], v[60:63]
  buffer_load_dwordx4 v[108:111], v7, s[24:27], s45 offen sc1
  s_add_u32 s45, s45, 144000
  s_waitcnt lgkmcnt(4)
  v_mfma_f32_16x16x32_bf16 v[32:35], v[24:27], v[208:211], v[32:35]
  ds_read_b64_tr_b16 v[20:21], v5 offset:4096
  v_mfma_f32_16x16x32_bf16 v[36:39], v[24:27], v[212:215], v[36:39]
  ds_read_b64_tr_b16 v[22:23], v5 offset:6144
  v_mfma_f32_16x16x32_bf16 v[40:43], v[24:27], v[216:219], v[40:43]
  buffer_load_dwordx4 v[112:115], v7, s[24:27], s45 offen sc1
  s_add_u32 s45, s45, 144000
  v_mfma_f32_16x16x32_bf16 v[44:47], v[24:27], v[220:223], v[44:47]
  buffer_load_dwordx4 v[116:119], v7, s[24:27], s45 offen sc1
  s_add_u32 s45, s45, 144000
  s_waitcnt lgkmcnt(4)
  v_mfma_f32_16x16x32_bf16 v[48:51], v[28:31], v[208:211], v[48:51]
  ds_read_b64_tr_b16 v[24:25], v3 offset:8192
  v_mfma_f32_16x16x32_bf16 v[52:55], v[28:31], v[212:215], v[52:55]
  ds_read_b64_tr_b16 v[26:27], v3 offset:10240
  v_mfma_f32_16x16x32_bf16 v[56:59], v[28:31], v[216:219], v[56:59]
  buffer_load_dwordx4 v[120:123], v7, s[24:27], s45 offen sc1
  s_add_u32 s45, s45, 144000
  v_mfma_f32_16x16x32_bf16 v[60:63], v[28:31], v[220:223], v[60:63]
  s_waitcnt lgkmcnt(4)
  v_mfma_f32_16x16x32_bf16 v[32:35], v[16:19], v[224:227], v[32:35]
  ds_read_b64_tr_b16 v[28:29], v5 offset:8192
  v_mfma_f32_16x16x32_bf16 v[36:39], v[16:19], v[228:231], v[36:39]
  ds_read_b64_tr_b16 v[30:31], v5 offset:10240
  v_mfma_f32_16x16x32_bf16 v[40:43], v[16:19], v[232:235], v[40:43]
  buffer_load_dwordx4 v[124:127], v7, s[24:27], s45 offen sc1
  s_add_u32 s45, s45, 144000
  v_mfma_f32_16x16x32_bf16 v[44:47], v[16:19], v[236:239], v[44:47]
  s_waitcnt lgkmcnt(4)
  v_mfma_f32_16x16x32_bf16 v[48:51], v[20:23], v[224:227], v[48:51]
  v_mfma_f32_16x16x32_bf16 v[52:55], v[20:23], v[228:231], v[52:55]
  v_mfma_f32_16x16x32_bf16 v[56:59], v[20:23], v[232:235], v[56:59]
  v_mfma_f32_16x16x32_bf16 v[60:63], v[20:23], v[236:239], v[60:63]
  s_waitcnt lgkmcnt(2)
  v_mfma_f32_16x16x32_bf16 v[32:35], v[24:27], v[240:243], v[32:35]
  v_mfma_f32_16x16x32_bf16 v[36:39], v[24:27], v[244:247], v[36:39]
  v_mfma_f32_16x16x32_bf16 v[40:43], v[24:27], v[248:251], v[40:43]
  v_mfma_f32_16x16x32_bf16 v[44:47], v[24:27], v[252:255], v[44:47]
  s_waitcnt lgkmcnt(0)
  v_mfma_f32_16x16x32_bf16 v[48:51], v[28:31], v[240:243], v[48:51]
  v_mfma_f32_16x16x32_bf16 v[52:55], v[28:31], v[244:247], v[52:55]
  v_mfma_f32_16x16x32_bf16 v[56:59], v[28:31], v[248:251], v[56:59]
  v_mfma_f32_16x16x32_bf16 v[60:63], v[28:31], v[252:255], v[60:63]
  v_cvt_pk_bf16_f32 v8, v32, v33
  v_cvt_pk_bf16_f32 v9, v34, v35
  v_cvt_pk_bf16_f32 v10, v36, v37
  v_cvt_pk_bf16_f32 v11, v38, v39
  buffer_store_dwordx4 v[8:11], v6, s[24:27], s46 offen offset:0 sc1
  v_cvt_pk_bf16_f32 v12, v40, v41
  v_cvt_pk_bf16_f32 v13, v42, v43
  v_cvt_pk_bf16_f32 v14, v44, v45
  v_cvt_pk_bf16_f32 v15, v46, v47
  buffer_store_dwordx4 v[12:15], v6, s[24:27], s46 offen offset:1024 sc1
  v_cvt_pk_bf16_f32 v8, v48, v49
  v_cvt_pk_bf16_f32 v9, v50, v51
  v_cvt_pk_bf16_f32 v10, v52, v53
  v_cvt_pk_bf16_f32 v11, v54, v55
  buffer_store_dwordx4 v[8:11], v6, s[24:27], s46 offen offset:2048 sc1
  v_cvt_pk_bf16_f32 v12, v56, v57
  v_cvt_pk_bf16_f32 v13, v58, v59
  v_cvt_pk_bf16_f32 v14, v60, v61
  v_cvt_pk_bf16_f32 v15, v62, v63
  buffer_store_dwordx4 v[12:15], v6, s[24:27], s46 offen offset:3072 sc1
  s_add_u32 s46, s46, 28672
  s_branch L_fin
L_p2b:
  s_waitcnt vmcnt(4) lgkmcnt(0)
  s_barrier
  ds_read_b128 v[64:67], v7 offset:0
  ds_read_b128 v[68:71], v7 offset:12288
  ds_read_b128 v[72:75], v8 offset:0
  ds_read_b64_tr_b16 v[16:17], v3 offset:0
  ds_read_b64_tr_b16 v[18:19], v3 offset:2048
  ds_read_b64_tr_b16 v[20:21], v5 offset:0
  ds_read_b64_tr_b16 v[22:23], v5 offset:2048
  ds_read_b64_tr_b16 v[24:25], v3 offset:4096
  ds_read_b64_tr_b16 v[26:27], v3 offset:6144
  s_waitcnt lgkmcnt(4)
  v_mfma_f32_16x16x32_bf16 v[32:35], v[16:19], v[64:67], 0
  ds_read_b128 v[80:83], v7 offset:1024
  ds_read_b128 v[84:87], v7 offset:13312
  s_add_u32 m0, s39, 0x3000
  s_add_u32 s45, s43, 245120
  buffer_load_dwordx4 v4, s[20:23], s45 offen  lds
  v_mfma_f32_16x16x32_bf16 v[36:39], v[16:19], v[68:71], 0
  ds_read_b128 v[88:91], v8 offset:1024
  ds_read_b64_tr_b16 v[28:29], v5 offset:4096
  v_mfma_f32_16x16x32_bf16 v[40:43], v[16:19], v[72:75], 0
  ds_read_b64_tr_b16 v[30:31], v5 offset:6144
  s_add_u32 m0, s39, 0x4000
  s_add_u32 s45, s43, 286080
  buffer_load_dwordx4 v4, s[20:23], s45 offen  lds
  s_waitcnt lgkmcnt(7)
  v_mfma_f32_16x16x32_bf16 v[48:51], v[20:23], v[64:67], 0
  ds_read_b128 v[96:99], v7 offset:2048
  ds_read_b128 v[100:103], v7 offset:14336
  v_mfma_f32_16x16x32_bf16 v[52:55], v[20:23], v[68:71], 0
  ds_read_b128 v[104:107], v8 offset:2048
  ds_read_b64_tr_b16 v[16:17], v3 offset:8192
  s_add_u32 m0, s39, 0x5000
  s_add_u32 s45, s43, 327040
  buffer_load_dwordx4 v4, s[20:23], s45 offen  lds
  v_mfma_f32_16x16x32_bf16 v[56:59], v[20:23], v[72:75], 0
  ds_read_b64_tr_b16 v[18:19], v3 offset:10240
  s_waitcnt lgkmcnt(7)
  v_mfma_f32_16x16x32_bf16 v[32:35], v[24:27], v[80:83], v[32:35]
  ds_read_b64_tr_b16 v[20:21], v5 offset:8192
  ds_read_b64_tr_b16 v[22:23], v5 offset:10240
  s_add_u32 m0, s39, 0x6000
  s_add_u32 s45, s43, 245760
  buffer_load_dwordx4 v4, s[20:23], s45 offen  lds
  v_mfma_f32_16x16x32_bf16 v[36:39], v[24:27], v[84:87], v[36:39]
  v_add_u32 v3, 73728, v2
  v_mfma_f32_16x16x32_bf16 v[40:43], v[24:27], v[88:91], v[40:43]
  v_xor_b32 v5, 32, v3
  s_add_u32 m0, s39, 0x7000
  s_add_u32 s45, s43, 286720
  buffer_load_dwordx4 v4, s[20:23], s45 offen  lds
  s_waitcnt lgkmcnt(7)
  v_mfma_f32_16x16x32_bf16 v[48:51], v[28:31], v[80:83], v[48:51]
  s_add_u32 m0, s39, 0x8000
  s_add_u32 s45, s43, 327680
  buffer_load_dwordx4 v4, s[20:23], s45 offen  lds
  v_mfma_f32_16x16x32_bf16 v[52:55], v[28:31], v[84:87], v[52:55]
  v_mfma_f32_16x16x32_bf16 v[56:59], v[28:31], v[88:91], v[56:59]
  s_waitcnt vmcnt(7) lgkmcnt(0)
  s_barrier
  v_mfma_f32_16x16x32_bf16 v[32:35], v[16:19], v[96:99], v[32:35]
  ds_read_b128 v[112:115], v7 offset:3072
  ds_read_b128 v[116:119], v7 offset:15360
  ds_read_b128 v[120:123], v8 offset:3072
  v_mfma_f32_16x16x32_bf16 v[36:39], v[16:19], v[100:103], v[36:39]
  ds_read_b64_tr_b16 v[24:25], v3 offset:0
  ds_read_b64_tr_b16 v[26:27], v3 offset:2048
  v_mfma_f32_16x16x32_bf16 v[40:43], v[16:19], v[104:107], v[40:43]
  ds_read_b64_tr_b16 v[28:29], v5 offset:0
  ds_read_b64_tr_b16 v[30:31], v5 offset:2048
  v_mfma_f32_16x16x32_bf16 v[48:51], v[20:23], v[96:99], v[48:51]
  ds_read_b64_tr_b16 v[16:17], v3 offset:4096
  v_mfma_f32_16x16x32_bf16 v[52:55], v[20:23], v[100:103], v[52:55]
  ds_read_b64_tr_b16 v[18:19], v3 offset:6144
  v_mfma_f32_16x16x32_bf16 v[56:59], v[20:23], v[104:107], v[56:59]
  s_add_u32 m0, s39, 0x9000
  s_add_u32 s45, s43, 368000
  buffer_load_dwordx4 v4, s[20:23], s45 offen  lds
  s_waitcnt lgkmcnt(4)
  v_mfma_f32_16x16x32_bf16 v[32:35], v[24:27], v[112:115], v[32:35]
  ds_read_b128 v[128:131], v7 offset:4096
  ds_read_b128 v[132:135], v7 offset:16384
  v_mfma_f32_16x16x32_bf16 v[36:39], v[24:27], v[116:119], v[36:39]
  ds_read_b128 v[136:139], v8 offset:4096
  ds_read_b64_tr_b16 v[20:21], v5 offset:4096
  v_mfma_f32_16x16x32_bf16 v[40:43], v[24:27], v[120:123], v[40:43]
  ds_read_b64_tr_b16 v[22:23], v5 offset:6144
  s_add_u32 m0, s39, 0xa000
  s_add_u32 s45, s43, 408960
  buffer_load_dwordx4 v4, s[20:23], s45 offen  lds
  s_waitcnt lgkmcnt(7)
  v_mfma_f32_16x16x32_bf16 v[48:51], v[28:31], v[112:115], v[48:51]
  ds_read_b128 v[144:147], v7 offset:5120
  ds_read_b128 v[148:151], v7 offset:17408
  v_mfma_f32_16x16x32_bf16 v[52:55], v[28:31], v[116:119], v[52:55]
  ds_read_b128 v[152:155], v8 offset:5120
  ds_read_b64_tr_b16 v[24:25], v3 offset:8192
  s_add_u32 m0, s39, 0xb000
  s_add_u32 s45, s43, 449920
  buffer_load_dwordx4 v4, s[20:23], s45 offen  lds
  v_mfma_f32_16x16x32_bf16 v[56:59], v[28:31], v[120:123], v[56:59]
  ds_read_b64_tr_b16 v[26:27], v3 offset:10240
  s_waitcnt lgkmcnt(7)
  v_mfma_f32_16x16x32_bf16 v[32:35], v[16:19], v[128:131], v[32:35]
  ds_read_b64_tr_b16 v[28:29], v5 offset:8192
  ds_read_b64_tr_b16 v[30:31], v5 offset:10240
  s_add_u32 m0, s39, 0xc000
  s_add_u32 s45, s43, 368640
  buffer_load_dwordx4 v4, s[20:23], s45 offen  lds
  v_mfma_f32_16x16x32_bf16 v[36:39], v[16:19], v[132:135], v[36:39]
  v_add_u32 v3, 24576, v2
  v_mfma_f32_16x16x32_bf16 v[40:43], v[16:19], v[136:139], v[40:43]
  v_xor_b32 v5, 32, v3
  s_add_u32 m0, s39, 0xd000
  s_add_u32 s45, s43, 409600
  buffer_load_dwordx4 v4, s[20:23], s45 offen  lds
  s_waitcnt lgkmcnt(7)
  v_mfma_f32_16x16x32_bf16 v[48:51], v[20:23], v[128:131], v[48:51]
  s_add_u32 m0, s39, 0xe000
  s_add_u32 s45, s43, 450560
  buffer_load_dwordx4 v4, s[20:23], s45 offen  lds
  v_mfma_f32_16x16x32_bf16 v[52:55], v[20:23], v[132:135], v[52:55]
  v_mfma_f32_16x16x32_bf16 v[56:59], v[20:23], v[136:139], v[56:59]
  s_waitcnt vmcnt(6) lgkmcnt(0)
  s_barrier
  v_mfma_f32_16x16x32_bf16 v[32:35], v[24:27], v[144:147], v[32:35]
  ds_read_b128 v[160:163], v7 offset:6144
  ds_read_b128 v[164:167], v7 offset:18432
  ds_read_b128 v[168:171], v8 offset:6144
  v_mfma_f32_16x16x32_bf16 v[36:39], v[24:27], v[148:151], v[36:39]
  ds_read_b64_tr_b16 v[16:17], v3 offset:0
  ds_read_b64_tr_b16 v[18:19], v3 offset:2048
  v_mfma_f32_16x16x32_bf16 v[40:43], v[24:27], v[152:155], v[40:43]
  ds_read_b64_tr_b16 v[20:21], v5 offset:0
  ds_read_b64_tr_b16 v[22:23], v5 offset:2048
  v_mfma_f32_16x16x32_bf16 v[48:51], v[28:31], v[144:147], v[48:51]
  ds_read_b64_tr_b16 v[24:25], v3 offset:4096
  v_mfma_f32_16x16x32_bf16 v[52:55], v[28:31], v[148:151], v[52:55]
  ds_read_b64_tr_b16 v[26:27], v3 offset:6144
  v_mfma_f32_16x16x32_bf16 v[56:59], v[28:31], v[152:155], v[56:59]
  s_add_u32 m0, s39, 0xf000
  s_add_u32 s45, s43, -512
  buffer_load_dwordx4 v4, s[20:23], s45 offen  lds
  s_waitcnt lgkmcnt(4)
  v_mfma_f32_16x16x32_bf16 v[32:35], v[16:19], v[160:163], v[32:35]
  ds_read_b128 v[176:179], v7 offset:7168
  ds_read_b128 v[180:183], v7 offset:19456
  v_mfma_f32_16x16x32_bf16 v[36:39], v[16:19], v[164:167], v[36:39]
  ds_read_b128 v[184:187], v8 offset:7168
  ds_read_b64_tr_b16 v[28:29], v5 offset:4096
  v_mfma_f32_16x16x32_bf16 v[40:43], v[16:19], v[168:171], v[40:43]
  ds_read_b64_tr_b16 v[30:31], v5 offset:6144
  s_add_u32 m0, s39, 0x10000
  s_add_u32 s45, s43, 40448
  buffer_load_dwordx4 v4, s[20:23], s45 offen  lds
  s_waitcnt lgkmcnt(7)
  v_mfma_f32_16x16x32_bf16 v[48:51], v[20:23], v[160:163], v[48:51]
  ds_read_b128 v[192:195], v7 offset:8192
  ds_read_b128 v[196:199], v7 offset:20480
  v_mfma_f32_16x16x32_bf16 v[52:55], v[20:23], v[164:167], v[52:55]
  ds_read_b128 v[200:203], v8 offset:8192
  ds_read_b64_tr_b16 v[16:17], v3 offset:8192
  s_add_u32 m0, s39, 0x11000
  s_add_u32 s45, s43, 81408
  buffer_load_dwordx4 v4, s[20:23], s45 offen  lds
  v_mfma_f32_16x16x32_bf16 v[56:59], v[20:23], v[168:171], v[56:59]
  ds_read_b64_tr_b16 v[18:19], v3 offset:10240
  s_waitcnt lgkmcnt(7)
  v_mfma_f32_16x16x32_bf16 v[32:35], v[24:27], v[176:179], v[32:35]
  ds_read_b64_tr_b16 v[20:21], v5 offset:8192
  ds_read_b64_tr_b16 v[22:23], v5 offset:10240
  s_add_u32 m0, s39, 0x12000
  s_add_u32 s45, s43, 128
  buffer_load_dwordx4 v4, s[20:23], s45 offen  lds
  v_mfma_f32_16x16x32_bf16 v[36:39], v[24:27], v[180:183], v[36:39]
  v_add_u32 v3, 49152, v2
  v_mfma_f32_16x16x32_bf16 v[40:43], v[24:27], v[184:187], v[40:43]
  v_xor_b32 v5, 32, v3
  s_add_u32 m0, s39, 0x13000
  s_add_u32 s45, s43, 41088
  buffer_load_dwordx4 v4, s[20:23], s45 offen  lds
  s_waitcnt lgkmcnt(7)
  v_mfma_f32_16x16x32_bf16 v[48:51], v[28:31], v[176:179], v[48:51]
  s_add_u32 m0, s39, 0x14000
  s_add_u32 s45, s43, 82048
  buffer_load_dwordx4 v4, s[20:23], s45 offen  lds
  v_mfma_f32_16x16x32_bf16 v[52:55], v[28:31], v[180:183], v[52:55]
  v_mfma_f32_16x16x32_bf16 v[56:59], v[28:31], v[184:187], v[56:59]
  s_waitcnt vmcnt(6) lgkmcnt(0)
  s_barrier
  v_mfma_f32_16x16x32_bf16 v[32:35], v[16:19], v[192:195], v[32:35]
  ds_read_b128 v[208:211], v7 offset:9216
  ds_read_b128 v[212:215], v7 offset:21504
  ds_read_b128 v[216:219], v8 offset:9216
  v_mfma_f32_16x16x32_bf16 v[36:39], v[16:19], v[196:199], v[36:39]
  ds_read_b64_tr_b16 v[24:25], v3 offset:0
  ds_read_b64_tr_b16 v[26:27], v3 offset:2048
  v_mfma_f32_16x16x32_bf16 v[40:43], v[16:19], v[200:203], v[40:43]
  ds_read_b64_tr_b16 v[28:29], v5 offset:0
  ds_read_b64_tr_b16 v[30:31], v5 offset:2048
  v_mfma_f32_16x16x32_bf16 v[48:51], v[20:23], v[192:195], v[48:51]
  ds_read_b64_tr_b16 v[16:17], v3 offset:4096
  v_mfma_f32_16x16x32_bf16 v[52:55], v[20:23], v[196:199], v[52:55]
  ds_read_b64_tr_b16 v[18:19], v3 offset:6144
  v_mfma_f32_16x16x32_bf16 v[56:59], v[20:23], v[200:203], v[56:59]
  s_add_u32 m0, s39, 0x3000
  s_add_u32 s45, s43, 122368
  buffer_load_dwordx4 v4, s[20:23], s45 offen  lds
  s_waitcnt lgkmcnt(4)
  v_mfma_f32_16x16x32_bf16 v[32:35], v[24:27], v[208:211], v[32:35]
  ds_read_b128 v[224:227], v7 offset:10240
  ds_read_b128 v[228:231], v7 offset:22528
  v_mfma_f32_16x16x32_bf16 v[36:39], v[24:27], v[212:215], v[36:39]
  ds_read_b128 v[232:235], v8 offset:10240
  ds_read_b64_tr_b16 v[20:21], v5 offset:4096
  v_mfma_f32_16x16x32_bf16 v[40:43], v[24:27], v[216:219], v[40:43]
  ds_read_b64_tr_b16 v[22:23], v5 offset:6144
  s_add_u32 m0, s39, 0x4000
  s_add_u32 s45, s43, 163328
  buffer_load_dwordx4 v4, s[20:23], s45 offen  lds
  s_waitcnt lgkmcnt(7)
  v_mfma_f32_16x16x32_bf16 v[48:51], v[28:31], v[208:211], v[48:51]
  ds_read_b128 v[240:243], v7 offset:11264
  ds_read_b128 v[244:247], v7 offset:23552
  v_mfma_f32_16x16x32_bf16 v[52:55], v[28:31], v[212:215], v[52:55]
  ds_read_b128 v[248:251], v8 offset:11264
  ds_read_b64_tr_b16 v[24:25], v3 offset:8192
  s_add_u32 m0, s39, 0x5000
  s_add_u32 s45, s43, 204288
  buffer_load_dwordx4 v4, s[20:23], s45 offen  lds
  v_mfma_f32_16x16x32_bf16 v[56:59], v[28:31], v[216:219], v[56:59]
  ds_read_b64_tr_b16 v[26:27], v3 offset:10240
  s_waitcnt lgkmcnt(7)
  v_mfma_f32_16x16x32_bf16 v[32:35], v[16:19], v[224:227], v[32:35]
  ds_read_b64_tr_b16 v[28:29], v5 offset:8192
  ds_read_b64_tr_b16 v[30:31], v5 offset:10240
  s_add_u32 m0, s39, 0x6000
  s_add_u32 s45, s43, 123008
  buffer_load_dwordx4 v4, s[20:23], s45 offen  lds
  v_mfma_f32_16x16x32_bf16 v[36:39], v[16:19], v[228:231], v[36:39]
  v_add_u32 v3, 73728, v2
  v_mfma_f32_16x16x32_bf16 v[40:43], v[16:19], v[232:235], v[40:43]
  v_xor_b32 v5, 32, v3
  s_add_u32 m0, s39, 0x7000
  s_add_u32 s45, s43, 163968
  buffer_load_dwordx4 v4, s[20:23], s45 offen  lds
  s_waitcnt lgkmcnt(7)
  v_mfma_f32_16x16x32_bf16 v[48:51], v[20:23], v[224:227], v[48:51]
  s_add_u32 m0, s39, 0x8000
  s_add_u32 s45, s43, 204928
  buffer_load_dwordx4 v4, s[20:23], s45 offen  lds
  v_mfma_f32_16x16x32_bf16 v[52:55], v[20:23], v[228:231], v[52:55]
  v_mfma_f32_16x16x32_bf16 v[56:59], v[20:23], v[232:235], v[56:59]
  s_waitcnt vmcnt(6) lgkmcnt(0)
  s_barrier
  v_mfma_f32_16x16x32_bf16 v[32:35], v[24:27], v[240:243], v[32:35]
  ds_read_b64_tr_b16 v[16:17], v3 offset:0
  ds_read_b64_tr_b16 v[18:19], v3 offset:2048
  v_mfma_f32_16x16x32_bf16 v[36:39], v[24:27], v[244:247], v[36:39]
  ds_read_b64_tr_b16 v[20:21], v5 offset:0
  v_mfma_f32_16x16x32_bf16 v[40:43], v[24:27], v[248:251], v[40:43]
  ds_read_b64_tr_b16 v[22:23], v5 offset:2048
  v_mfma_f32_16x16x32_bf16 v[48:51], v[28:31], v[240:243], v[48:51]
  ds_read_b64_tr_b16 v[24:25], v3 offset:4096
  v_mfma_f32_16x16x32_bf16 v[52:55], v[28:31], v[244:247], v[52:55]
  ds_read_b64_tr_b16 v[26:27], v3 offset:6144
  v_mfma_f32_16x16x32_bf16 v[56:59], v[28:31], v[248:251], v[56:59]
  s_add_u32 m0, s39, 0xffffd000
  s_add_u32 s45, s43, 245248
  buffer_load_dwordx4 v4, s[20:23], s45 offen  lds
  s_waitcnt lgkmcnt(4)
  v_cvt_pk_bf16_f32 v8, v32, v33
  v_cvt_pk_bf16_f32 v9, v34, v35
  v_mfma_f32_16x16x32_bf16 v[32:35], v[16:19], v[64:67], 0
  ds_read_b64_tr_b16 v[28:29], v5 offset:4096
  v_cvt_pk_bf16_f32 v10, v36, v37
  v_cvt_pk_bf16_f32 v11, v38, v39
  v_mfma_f32_16x16x32_bf16 v[36:39], v[16:19], v[68:71], 0
  buffer_store_dwordx4 v[8:11], v6, s[24:27], s46 offen offset:0 sc1
  ds_read_b64_tr_b16 v[30:31], v5 offset:6144
  v_cvt_pk_bf16_f32 v12, v40, v41
  v_cvt_pk_bf16_f32 v13, v42, v43
  v_mfma_f32_16x16x32_bf16 v[40:43], v[16:19], v[72:75], 0
  buffer_store_dwordx2 v[12:13], v0, s[24:27], s76 offen offset:0 sc1
  s_add_u32 m0, s39, 0xffffe000
  s_add_u32 s45, s43, 286208
  buffer_load_dwordx4 v4, s[20:23], s45 offen  lds
  s_waitcnt lgkmcnt(4)
  v_cvt_pk_bf16_f32 v8, v48, v49
  v_cvt_pk_bf16_f32 v9, v50, v51
  v_mfma_f32_16x16x32_bf16 v[48:51], v[20:23], v[64:67], 0
  ds_read_b64_tr_b16 v[16:17], v3 offset:8192
  v_cvt_pk_bf16_f32 v10, v52, v53
  v_cvt_pk_bf16_f32 v11, v54, v55
  v_mfma_f32_16x16x32_bf16 v[52:55], v[20:23], v[68:71], 0
  buffer_store_dwordx4 v[8:11], v6, s[24:27], s46 offen offset:1024 sc1
  ds_read_b64_tr_b16 v[18:19], v3 offset:10240
  s_add_u32 m0, s39, 0xfffff000
  s_add_u32 s45, s43, 327168
  buffer_load_dwordx4 v4, s[20:23], s45 offen  lds
  v_cvt_pk_bf16_f32 v12, v56, v57
  v_cvt_pk_bf16_f32 v13, v58, v59
  v_mfma_f32_16x16x32_bf16 v[56:59], v[20:23], v[72:75], 0
  buffer_store_dwordx2 v[12:13], v0, s[24:27], s76 offen offset:512 sc1
  s_add_u32 s46, s46, 28672
  s_add_u32 s76, s76, 28672
  s_add_u32 m0, s39, 0x0
  s_add_u32 s45, s43, 245888
  buffer_load_dwordx4 v4, s[20:23], s45 offen  lds
  s_waitcnt lgkmcnt(4)
  v_mfma_f32_16x16x32_bf16 v[32:35], v[24:27], v[80:83], v[32:35]
  ds_read_b64_tr_b16 v[20:21], v5 offset:8192
  ds_read_b64_tr_b16 v[22:23], v5 offset:10240
  v_mfma_f32_16x16x32_bf16 v[36:39], v[24:27], v[84:87], v[36:39]
  v_add_u32 v3, 24576, v2
  v_mfma_f32_16x16x32_bf16 v[40:43], v[24:27], v[88:91], v[40:43]
  v_xor_b32 v5, 32, v3
  s_add_u32 m0, s39, 0x1000
  s_add_u32 s45, s43, 286848
  buffer_load_dwordx4 v4, s[20:23], s45 offen  lds
  s_waitcnt lgkmcnt(4)
  v_mfma_f32_16x16x32_bf16 v[48:51], v[28:31], v[80:83], v[48:51]
  s_add_u32 m0, s39, 0x2000
  s_add_u32 s45, s43, 327808
  buffer_load_dwordx4 v4, s[20:23], s45 offen  lds
  v_mfma_f32_16x16x32_bf16 v[52:55], v[28:31], v[84:87], v[52:55]
  v_mfma_f32_16x16x32_bf16 v[56:59], v[28:31], v[88:91], v[56:59]
  s_waitcnt vmcnt(10) lgkmcnt(0)
  s_barrier
  v_mfma_f32_16x16x32_bf16 v[32:35], v[16:19], v[96:99], v[32:35]
  ds_read_b64_tr_b16 v[24:25], v3 offset:0
  ds_read_b64_tr_b16 v[26:27], v3 offset:2048
  s_add_u32 m0, s39, 0x15000
  s_add_u32 s45, s43, 368128
  buffer_load_dwordx4 v4, s[20:23], s45 offen  lds
  v_mfma_f32_16x16x32_bf16 v[36:39], v[16:19], v[100:103], v[36:39]
  ds_read_b64_tr_b16 v[28:29], v5 offset:0
  s_add_u32 m0, s39, 0x16000
  s_add_u32 s45, s43, 409088
  buffer_load_dwordx4 v4, s[20:23], s45 offen  lds
  v_mfma_f32_16x16x32_bf16 v[40:43], v[16:19], v[104:107], v[40:43]
  ds_read_b64_tr_b16 v[30:31], v5 offset:2048
  s_add_u32 m0, s39, 0x17000
  s_add_u32 s45, s43, 450048
  buffer_load_dwordx4 v4, s[20:23], s45 offen  lds
  v_mfma_f32_16x16x32_bf16 v[48:51], v[20:23], v[96:99], v[48:51]
  ds_read_b64_tr_b16 v[16:17], v3 offset:4096
  s_add_u32 m0, s39, 0x18000
  s_add_u32 s45, s43, 368768
  buffer_load_dwordx4 v4, s[20:23], s45 offen  lds
  v_mfma_f32_16x16x32_bf16 v[52:55], v[20:23], v[100:103], v[52:55]
  ds_read_b64_tr_b16 v[18:19], v3 offset:6144
  s_add_u32 m0, s39, 0x19000
  s_add_u32 s45, s43, 409728
  buffer_load_dwordx4 v4, s[20:23], s45 offen  lds
  v_mfma_f32_16x16x32_bf16 v[56:59], v[20:23], v[104:107], v[56:59]
  s_add_u32 m0, s39, 0x1a000
  s_add_u32 s45, s43, 450688
  buffer_load_dwordx4 v4, s[20:23], s45 offen  lds
  s_waitcnt lgkmcnt(4)
  v_mfma_f32_16x16x32_bf16 v[32:35], v[24:27], v[112:115], v[32:35]
  ds_read_b64_tr_b16 v[20:21], v5 offset:4096
  s_add_u32 m0, s39, 0x1b000
  s_add_u32 s45, s43, -384
  buffer_load_dwordx4 v4, s[20:23], s45 offen  lds
  v_mfma_f32_16x16x32_bf16 v[36:39], v[24:27], v[116:119], v[36:39]
  ds_read_b64_tr_b16 v[22:23], v5 offset:6144
  v_mfma_f32_16x16x32_bf16 v[40:43], v[24:27], v[120:123], v[40:43]
  s_add_u32 m0, s39, 0x1c000
  s_add_u32 s45, s43, 40576
  buffer_load_dwordx4 v4, s[20:23], s45 offen  lds
  s_waitcnt lgkmcnt(4)
  v_mfma_f32_16x16x32_bf16 v[48:51], v[28:31], v[112:115], v[48:51]
  ds_read_b64_tr_b16 v[24:25], v3 offset:8192
  v_mfma_f32_16x16x32_bf16 v[52:55], v[28:31], v[116:119], v[52:55]
  ds_read_b64_tr_b16 v[26:27], v3 offset:10240
  s_add_u32 m0, s39, 0x1d000
  s_add_u32 s45, s43, 81536
  buffer_load_dwordx4 v4, s[20:23], s45 offen  lds
  v_mfma_f32_16x16x32_bf16 v[56:59], v[28:31], v[120:123], v[56:59]
  s_add_u32 m0, s39, 0x1e000
  s_add_u32 s45, s43, 256
  buffer_load_dwordx4 v4, s[20:23], s45 offen  lds
  s_waitcnt lgkmcnt(4)
  v_mfma_f32_16x16x32_bf16 v[32:35], v[16:19], v[128:131], v[32:35]
  ds_read_b64_tr_b16 v[28:29], v5 offset:8192
  ds_read_b64_tr_b16 v[30:31], v5 offset:10240
  v_mfma_f32_16x16x32_bf16 v[36:39], v[16:19], v[132:135], v[36:39]
  v_add_u32 v3, 0, v2
  v_mfma_f32_16x16x32_bf16 v[40:43], v[16:19], v[136:139], v[40:43]
  v_xor_b32 v5, 32, v3
  s_add_u32 m0, s39, 0x1f000
  s_add_u32 s45, s43, 41216
  buffer_load_dwordx4 v4, s[20:23], s45 offen  lds
  s_waitcnt lgkmcnt(4)
  v_mfma_f32_16x16x32_bf16 v[48:51], v[20:23], v[128:131], v[48:51]
  s_add_u32 m0, s39, 0x20000
  s_add_u32 s45, s43, 82176
  buffer_load_dwordx4 v4, s[20:23], s45 offen  lds
  v_mfma_f32_16x16x32_bf16 v[52:55], v[20:23], v[132:135], v[52:55]
  v_mfma_f32_16x16x32_bf16 v[56:59], v[20:23], v[136:139], v[56:59]
  s_waitcnt vmcnt(12) lgkmcnt(0)
  s_barrier
  v_mfma_f32_16x16x32_bf16 v[32:35], v[24:27], v[144:147], v[32:35]
  ds_read_b64_tr_b16 v[16:17], v3 offset:0
  ds_read_b64_tr_b16 v[18:19], v3 offset:2048
  s_add_u32 m0, s39, 0x9000
  s_add_u32 s45, s43, 122496
  buffer_load_dwordx4 v4, s[20:23], s45 offen  lds
  v_mfma_f32_16x16x32_bf16 v[36:39], v[24:27], v[148:151], v[36:39]
  ds_read_b64_tr_b16 v[20:21], v5 offset:0
  s_add_u32 m0, s39, 0xa000
  s_add_u32 s45, s43, 163456
  buffer_load_dwordx4 v4, s[20:23], s45 offen  lds
  v_mfma_f32_16x16x32_bf16 v[40:43], v[24:27], v[152:155], v[40:43]
  ds_read_b64_tr_b16 v[22:23], v5 offset:2048
  s_add_u32 m0, s39, 0xb000
  s_add_u32 s45, s43, 204416
  buffer_load_dwordx4 v4, s[20:23], s45 offen  lds
  v_mfma_f32_16x16x32_bf16 v[48:51], v[28:31], v[144:147], v[48:51]
  ds_read_b64_tr_b16 v[24:25], v3 offset:4096
  s_add_u32 m0, s39, 0xc000
  s_add_u32 s45, s43, 123136
  buffer_load_dwordx4 v4, s[20:23], s45 offen  lds
  v_mfma_f32_16x16x32_bf16 v[52:55], v[28:31], v[148:151], v[52:55]
  ds_read_b64_tr_b16 v[26:27], v3 offset:6144
  s_add_u32 m0, s39, 0xd000
  s_add_u32 s45, s43, 164096
  buffer_load_dwordx4 v4, s[20:23], s45 offen  lds
  v_mfma_f32_16x16x32_bf16 v[56:59], v[28:31], v[152:155], v[56:59]
  s_add_u32 m0, s39, 0xe000
  s_add_u32 s45, s43, 205056
  buffer_load_dwordx4 v4, s[20:23], s45 offen  lds
  s_waitcnt lgkmcnt(4)
  v_mfma_f32_16x16x32_bf16 v[32:35], v[16:19], v[160:163], v[32:35]
  ds_read_b64_tr_b16 v[28:29], v5 offset:4096
  s_add_u32 m0, s39, 0xf000
  s_add_u32 s45, s43, 245376
  buffer_load_dwordx4 v4, s[20:23], s45 offen  lds
  v_mfma_f32_16x16x32_bf16 v[36:39], v[16:19], v[164:167], v[36:39]
  ds_read_b64_tr_b16 v[30:31], v5 offset:6144
  v_mfma_f32_16x16x32_bf16 v[40:43], v[16:19], v[168:171], v[40:43]
  s_add_u32 m0, s39, 0x10000
  s_add_u32 s45, s43, 286336
  buffer_load_dwordx4 v4, s[20:23], s45 offen  lds
  s_waitcnt lgkmcnt(4)
  v_mfma_f32_16x16x32_bf16 v[48:51], v[20:23], v[160:163], v[48:51]
  ds_read_b64_tr_b16 v[16:17], v3 offset:8192
  v_mfma_f32_16x16x32_bf16 v[52:55], v[20:23], v[164:167], v[52:55]
  ds_read_b64_tr_b16 v[18:19], v3 offset:10240
  s_add_u32 m0, s39, 0x11000
  s_add_u32 s45, s43, 327296
  buffer_load_dwordx4 v4, s[20:23], s45 offen  lds
  v_mfma_f32_16x16x32_bf16 v[56:59], v[20:23], v[168:171], v[56:59]
  s_add_u32 m0, s39, 0x12000
  s_add_u32 s45, s43, 246016
  buffer_load_dwordx4 v4, s[20:23], s45 offen  lds
  s_waitcnt lgkmcnt(4)
  v_mfma_f32_16x16x32_bf16 v[32:35], v[24:27], v[176:179], v[32:35]
  ds_read_b64_tr_b16 v[20:21], v5 offset:8192
  ds_read_b64_tr_b16 v[22:23], v5 offset:10240
  v_mfma_f32_16x16x32_bf16 v[36:39], v[24:27], v[180:183], v[36:39]
  v_add_u32 v3, 98304, v2
  v_mfma_f32_16x16x32_bf16 v[40:43], v[24:27], v[184:187], v[40:43]
  v_xor_b32 v5, 32, v3
  s_add_u32 m0, s39, 0x13000
  s_add_u32 s45, s43, 286976
  buffer_load_dwordx4 v4, s[20:23], s45 offen  lds
  s_waitcnt lgkmcnt(4)
  v_mfma_f32_16x16x32_bf16 v[48:51], v[28:31], v[176:179], v[48:51]
  s_add_u32 m0, s39, 0x14000
  s_add_u32 s45, s43, 327936
  buffer_load_dwordx4 v4, s[20:23], s45 offen  lds
  v_mfma_f32_16x16x32_bf16 v[52:55], v[28:31], v[180:183], v[52:55]
  v_mfma_f32_16x16x32_bf16 v[56:59], v[28:31], v[184:187], v[56:59]
  s_waitcnt vmcnt(18) lgkmcnt(0)
  s_barrier
  v_mfma_f32_16x16x32_bf16 v[32:35], v[16:19], v[192:195], v[32:35]
  ds_read_b64_tr_b16 v[24:25], v3 offset:0
  ds_read_b64_tr_b16 v[26:27], v3 offset:2048
  s_add_u32 m0, s39, 0x3000
  s_add_u32 s45, s43, 368256
  buffer_load_dwordx4 v4, s[20:23], s45 offen  lds
  v_mfma_f32_16x16x32_bf16 v[36:39], v[16:19], v[196:199], v[36:39]
  ds_read_b64_tr_b16 v[28:29], v5 offset:0
  s_add_u32 m0, s39, 0x4000
  s_add_u32 s45, s43, 409216
  buffer_load_dwordx4 v4, s[20:23], s45 offen  lds
  v_mfma_f32_16x16x32_bf16 v[40:43], v[16:19], v[200:203], v[40:43]
  ds_read_b64_tr_b16 v[30:31], v5 offset:2048
  s_add_u32 m0, s39, 0x5000
  s_add_u32 s45, s43, 450176
  buffer_load_dwordx4 v4, s[20:23], s45 offen  lds
  v_mfma_f32_16x16x32_bf16 v[48:51], v[20:23], v[192:195], v[48:51]
  ds_read_b64_tr_b16 v[16:17], v3 offset:4096
  s_add_u32 m0, s39, 0x6000
  s_add_u32 s45, s43, 368896
  buffer_load_dwordx4 v4, s[20:23], s45 offen  lds
  v_mfma_f32_16x16x32_bf16 v[52:55], v[20:23], v[196:199], v[52:55]
  ds_read_b64_tr_b16 v[18:19], v3 offset:6144
  s_add_u32 m0, s39, 0x7000
  s_add_u32 s45, s43, 409856
  buffer_load_dwordx4 v4, s[20:23], s45 offen  lds
  v_mfma_f32_16x16x32_bf16 v[56:59], v[20:23], v[200:203], v[56:59]
  s_add_u32 m0, s39, 0x8000
  s_add_u32 s45, s43, 450816
  buffer_load_dwordx4 v4, s[20:23], s45 offen  lds
  s_waitcnt lgkmcnt(4)
  v_mfma_f32_16x16x32_bf16 v[32:35], v[24:27], v[208:211], v[32:35]
  ds_read_b64_tr_b16 v[20:21], v5 offset:4096
  s_add_u32 m0, s39, 0xffffd000
  s_add_u32 s45, s43, -256
  buffer_load_dwordx4 v4, s[20:23], s45 offen  lds
  v_mfma_f32_16x16x32_bf16 v[36:39], v[24:27], v[212:215], v[36:39]
  ds_read_b64_tr_b16 v[22:23], v5 offset:6144
  v_mfma_f32_16x16x32_bf16 v[40:43], v[24:27], v[216:219], v[40:43]
  s_add_u32 m0, s39, 0xffffe000
  s_add_u32 s45, s43, 40704
  buffer_load_dwordx4 v4, s[20:23], s45 offen  lds
  s_waitcnt lgkmcnt(4)
  v_mfma_f32_16x16x32_bf16 v[48:51], v[28:31], v[208:211], v[48:51]
  ds_read_b64_tr_b16 v[24:25], v3 offset:8192
  v_mfma_f32_16x16x32_bf16 v[52:55], v[28:31], v[212:215], v[52:55]
  ds_read_b64_tr_b16 v[26:27], v3 offset:10240
  s_add_u32 m0, s39, 0xfffff000
  s_add_u32 s45, s43, 81664
  buffer_load_dwordx4 v4, s[20:23], s45 offen  lds
  v_mfma_f32_16x16x32_bf16 v[56:59], v[28:31], v[216:219], v[56:59]
  s_add_u32 m0, s39, 0x0
  s_add_u32 s45, s43, 384
  buffer_load_dwordx4 v4, s[20:23], s45 offen  lds
  s_waitcnt lgkmcnt(4)
  v_mfma_f32_16x16x32_bf16 v[32:35], v[16:19], v[224:227], v[32:35]
  ds_read_b64_tr_b16 v[28:29], v5 offset:8192
  ds_read_b64_tr_b16 v[30:31], v5 offset:10240
  v_mfma_f32_16x16x32_bf16 v[36:39], v[16:19], v[228:231], v[36:39]
  v_add_u32 v3, 122880, v2
  v_mfma_f32_16x16x32_bf16 v[40:43], v[16:19], v[232:235], v[40:43]
  v_xor_b32 v5, 32, v3
  s_add_u32 m0, s39, 0x1000
  s_add_u32 s45, s43, 41344
  buffer_load_dwordx4 v4, s[20:23], s45 offen  lds
  s_waitcnt lgkmcnt(4)
  v_mfma_f32_16x16x32_bf16 v[48:51], v[20:23], v[224:227], v[48:51]
  s_add_u32 m0, s39, 0x2000
  s_add_u32 s45, s43, 82304
  buffer_load_dwordx4 v4, s[20:23], s45 offen  lds
  v_mfma_f32_16x16x32_bf16 v[52:55], v[20:23], v[228:231], v[52:55]
  v_mfma_f32_16x16x32_bf16 v[56:59], v[20:23], v[232:235], v[56:59]
  s_waitcnt vmcnt(24) lgkmcnt(0)
  s_barrier
  v_mfma_f32_16x16x32_bf16 v[32:35], v[24:27], v[240:243], v[32:35]
  ds_read_b64_tr_b16 v[16:17], v3 offset:0
  ds_read_b64_tr_b16 v[18:19], v3 offset:2048
  v_mfma_f32_16x16x32_bf16 v[36:39], v[24:27], v[244:247], v[36:39]
  ds_read_b64_tr_b16 v[20:21], v5 offset:0
  v_mfma_f32_16x16x32_bf16 v[40:43], v[24:27], v[248:251], v[40:43]
  ds_read_b64_tr_b16 v[22:23], v5 offset:2048
  v_mfma_f32_16x16x32_bf16 v[48:51], v[28:31], v[240:243], v[48:51]
  ds_read_b64_tr_b16 v[24:25], v3 offset:4096
  v_mfma_f32_16x16x32_bf16 v[52:55], v[28:31], v[244:247], v[52:55]
  ds_read_b64_tr_b16 v[26:27], v3 offset:6144
  v_mfma_f32_16x16x32_bf16 v[56:59], v[28:31], v[248:251], v[56:59]
  s_waitcnt lgkmcnt(4)
  v_cvt_pk_bf16_f32 v8, v32, v33
  v_cvt_pk_bf16_f32 v9, v34, v35
  v_mfma_f32_16x16x32_bf16 v[32:35], v[16:19], v[64:67], 0
  ds_read_b64_tr_b16 v[28:29], v5 offset:4096
  v_cvt_pk_bf16_f32 v10, v36, v37
  v_cvt_pk_bf16_f32 v11, v38, v39
  v_mfma_f32_16x16x32_bf16 v[36:39], v[16:19], v[68:71], 0
  buffer_store_dwordx4 v[8:11], v6, s[24:27], s46 offen offset:0 sc1
  ds_read_b64_tr_b16 v[30:31], v5 offset:6144
  v_cvt_pk_bf16_f32 v12, v40, v41
  v_cvt_pk_bf16_f32 v13, v42, v43
  v_mfma_f32_16x16x32_bf16 v[40:43], v[16:19], v[72:75], 0
  buffer_store_dwordx2 v[12:13], v0, s[24:27], s76 offen offset:0 sc1
  s_waitcnt lgkmcnt(4)
  v_cvt_pk_bf16_f32 v8, v48, v49
  v_cvt_pk_bf16_f32 v9, v50, v51
  v_mfma_f32_16x16x32_bf16 v[48:51], v[20:23], v[64:67], 0
  ds_read_b64_tr_b16 v[16:17], v3 offset:8192
  v_cvt_pk_bf16_f32 v10, v52, v53
  v_cvt_pk_bf16_f32 v11, v54, v55
  v_mfma_f32_16x16x32_bf16 v[52:55], v[20:23], v[68:71], 0
  buffer_store_dwordx4 v[8:11], v6, s[24:27], s46 offen offset:1024 sc1
  ds_read_b64_tr_b16 v[18:19], v3 offset:10240
  v_cvt_pk_bf16_f32 v12, v56, v57
  v_cvt_pk_bf16_f32 v13, v58, v59
  v_mfma_f32_16x16x32_bf16 v[56:59], v[20:23], v[72:75], 0
  buffer_store_dwordx2 v[12:13], v0, s[24:27], s76 offen offset:512 sc1
  s_add_u32 s46, s46, 28672
  s_add_u32 s76, s76, 28672
  s_waitcnt lgkmcnt(4)
  v_mfma_f32_16x16x32_bf16 v[32:35], v[24:27], v[80:83], v[32:35]
  ds_read_b64_tr_b16 v[20:21], v5 offset:8192
  ds_read_b64_tr_b16 v[22:23], v5 offset:10240
  v_mfma_f32_16x16x32_bf16 v[36:39], v[24:27], v[84:87], v[36:39]
  v_add_u32 v3, 49152, v2
  v_mfma_f32_16x16x32_bf16 v[40:43], v[24:27], v[88:91], v[40:43]
  v_xor_b32 v5, 32, v3
  s_waitcnt lgkmcnt(4)
  v_mfma_f32_16x16x32_bf16 v[48:51], v[28:31], v[80:83], v[48:51]
  v_mfma_f32_16x16x32_bf16 v[52:55], v[28:31], v[84:87], v[52:55]
  v_mfma_f32_16x16x32_bf16 v[56:59], v[28:31], v[88:91], v[56:59]
  s_waitcnt vmcnt(22) lgkmcnt(0)
  s_barrier
  v_mfma_f32_16x16x32_bf16 v[32:35], v[16:19], v[96:99], v[32:35]
  ds_read_b64_tr_b16 v[24:25], v3 offset:0
  ds_read_b64_tr_b16 v[26:27], v3 offset:2048
  v_mfma_f32_16x16x32_bf16 v[36:39], v[16:19], v[100:103], v[36:39]
  ds_read_b64_tr_b16 v[28:29], v5 offset:0
  v_mfma_f32_16x16x32_bf16 v[40:43], v[16:19], v[104:107], v[40:43]
  ds_read_b64_tr_b16 v[30:31], v5 offset:2048
  v_mfma_f32_16x16x32_bf16 v[48:51], v[20:23], v[96:99], v[48:51]
  ds_read_b64_tr_b16 v[16:17], v3 offset:4096
  v_mfma_f32_16x16x32_bf16 v[52:55], v[20:23], v[100:103], v[52:55]
  ds_read_b64_tr_b16 v[18:19], v3 offset:6144
  v_mfma_f32_16x16x32_bf16 v[56:59], v[20:23], v[104:107], v[56:59]
  s_waitcnt lgkmcnt(4)
  v_mfma_f32_16x16x32_bf16 v[32:35], v[24:27], v[112:115], v[32:35]
  ds_read_b64_tr_b16 v[20:21], v5 offset:4096
  v_mfma_f32_16x16x32_bf16 v[36:39], v[24:27], v[116:119], v[36:39]
  ds_read_b64_tr_b16 v[22:23], v5 offset:6144
  v_mfma_f32_16x16x32_bf16 v[40:43], v[24:27], v[120:123], v[40:43]
  s_waitcnt lgkmcnt(4)
  v_mfma_f32_16x16x32_bf16 v[48:51], v[28:31], v[112:115], v[48:51]
  ds_read_b64_tr_b16 v[24:25], v3 offset:8192
  v_mfma_f32_16x16x32_bf16 v[52:55], v[28:31], v[116:119], v[52:55]
  ds_read_b64_tr_b16 v[26:27], v3 offset:10240
  v_mfma_f32_16x16x32_bf16 v[56:59], v[28:31], v[120:123], v[56:59]
  s_waitcnt lgkmcnt(4)
  v_mfma_f32_16x16x32_bf16 v[32:35], v[16:19], v[128:131], v[32:35]
  ds_read_b64_tr_b16 v[28:29], v5 offset:8192
  ds_read_b64_tr_b16 v[30:31], v5 offset:10240
  v_mfma_f32_16x16x32_bf16 v[36:39], v[16:19], v[132:135], v[36:39]
  v_add_u32 v3, 73728, v2
  v_mfma_f32_16x16x32_bf16 v[40:43], v[16:19], v[136:139], v[40:43]
  v_xor_b32 v5, 32, v3
  s_waitcnt lgkmcnt(4)
  v_mfma_f32_16x16x32_bf16 v[48:51], v[20:23], v[128:131], v[48:51]
  v_mfma_f32_16x16x32_bf16 v[52:55], v[20:23], v[132:135], v[52:55]
  v_mfma_f32_16x16x32_bf16 v[56:59], v[20:23], v[136:139], v[56:59]
  s_waitcnt vmcnt(16) lgkmcnt(0)
  s_barrier
  v_mfma_f32_16x16x32_bf16 v[32:35], v[24:27], v[144:147], v[32:35]
  ds_read_b64_tr_b16 v[16:17], v3 offset:0
  ds_read_b64_tr_b16 v[18:19], v3 offset:2048
  s_add_u32 m0, s39, 0x15000
  s_add_u32 s45, s43, 122624
  buffer_load_dwordx4 v4, s[20:23], s45 offen  lds
  v_mfma_f32_16x16x32_bf16 v[36:39], v[24:27], v[148:151], v[36:39]
  ds_read_b64_tr_b16 v[20:21], v5 offset:0
  s_add_u32 m0, s39, 0x16000
  s_add_u32 s45, s43, 163584
  buffer_load_dwordx4 v4, s[20:23], s45 offen  lds
  v_mfma_f32_16x16x32_bf16 v[40:43], v[24:27], v[152:155], v[40:43]
  ds_read_b64_tr_b16 v[22:23], v5 offset:2048
  s_add_u32 m0, s39, 0x17000
  s_add_u32 s45, s43, 204544
  buffer_load_dwordx4 v4, s[20:23], s45 offen  lds
  v_mfma_f32_16x16x32_bf16 v[48:51], v[28:31], v[144:147], v[48:51]
  ds_read_b64_tr_b16 v[24:25], v3 offset:4096
  s_add_u32 m0, s39, 0x18000
  s_add_u32 s45, s43, 123264
  buffer_load_dwordx4 v4, s[20:23], s45 offen  lds
  v_mfma_f32_16x16x32_bf16 v[52:55], v[28:31], v[148:151], v[52:55]
  ds_read_b64_tr_b16 v[26:27], v3 offset:6144
  s_add_u32 m0, s39, 0x19000
  s_add_u32 s45, s43, 164224
  buffer_load_dwordx4 v4, s[20:23], s45 offen  lds
  v_mfma_f32_16x16x32_bf16 v[56:59], v[28:31], v[152:155], v[56:59]
  s_add_u32 m0, s39, 0x1a000
  s_add_u32 s45, s43, 205184
  buffer_load_dwordx4 v4, s[20:23], s45 offen  lds
  s_waitcnt lgkmcnt(4)
  v_mfma_f32_16x16x32_bf16 v[32:35], v[16:19], v[160:163], v[32:35]
  ds_read_b64_tr_b16 v[28:29], v5 offset:4096
  s_add_u32 m0, s39, 0x1b000
  s_add_u32 s45, s43, 245504
  buffer_load_dwordx4 v4, s[20:23], s45 offen  lds
  v_mfma_f32_16x16x32_bf16 v[36:39], v[16:19], v[164:167], v[36:39]
  ds_read_b64_tr_b16 v[30:31], v5 offset:6144
  v_mfma_f32_16x16x32_bf16 v[40:43], v[16:19], v[168:171], v[40:43]
  s_add_u32 m0, s39, 0x1c000
  s_add_u32 s45, s43, 286464
  buffer_load_dwordx4 v4, s[20:23], s45 offen  lds
  s_waitcnt lgkmcnt(4)
  v_mfma_f32_16x16x32_bf16 v[48:51], v[20:23], v[160:163], v[48:51]
  ds_read_b64_tr_b16 v[16:17], v3 offset:8192
  v_mfma_f32_16x16x32_bf16 v[52:55], v[20:23], v[164:167], v[52:55]
  ds_read_b64_tr_b16 v[18:19], v3 offset:10240
  s_add_u32 m0, s39, 0x1d000
  s_add_u32 s45, s43, 327424
  buffer_load_dwordx4 v4, s[20:23], s45 offen  lds
  v_mfma_f32_16x16x32_bf16 v[56:59], v[20:23], v[168:171], v[56:59]
  s_add_u32 m0, s39, 0x1e000
  s_add_u32 s45, s43, 246144
  buffer_load_dwordx4 v4, s[20:23], s45 offen  lds
  s_waitcnt lgkmcnt(4)
  v_mfma_f32_16x16x32_bf16 v[32:35], v[24:27], v[176:179], v[32:35]
  ds_read_b64_tr_b16 v[20:21], v5 offset:8192
  ds_read_b64_tr_b16 v[22:23], v5 offset:10240
  v_mfma_f32_16x16x32_bf16 v[36:39], v[24:27], v[180:183], v[36:39]
  v_add_u32 v3, 24576, v2
  v_mfma_f32_16x16x32_bf16 v[40:43], v[24:27], v[184:187], v[40:43]
  v_xor_b32 v5, 32, v3
  s_add_u32 m0, s39, 0x1f000
  s_add_u32 s45, s43, 287104
  buffer_load_dwordx4 v4, s[20:23], s45 offen  lds
  s_waitcnt lgkmcnt(4)
  v_mfma_f32_16x16x32_bf16 v[48:51], v[28:31], v[176:179], v[48:51]
  s_add_u32 m0, s39, 0x20000
  s_add_u32 s45, s43, 328064
  buffer_load_dwordx4 v4, s[20:23], s45 offen  lds
  v_mfma_f32_16x16x32_bf16 v[52:55], v[28:31], v[180:183], v[52:55]
  v_mfma_f32_16x16x32_bf16 v[56:59], v[28:31], v[184:187], v[56:59]
  s_waitcnt vmcnt(12) lgkmcnt(0)
  s_barrier
  v_mfma_f32_16x16x32_bf16 v[32:35], v[16:19], v[192:195], v[32:35]
  ds_read_b64_tr_b16 v[24:25], v3 offset:0
  ds_read_b64_tr_b16 v[26:27], v3 offset:2048
  s_add_u32 m0, s39, 0x9000
  s_add_u32 s45, s43, 368384
  buffer_load_dwordx4 v4, s[20:23], s45 offen  lds
  v_mfma_f32_16x16x32_bf16 v[36:39], v[16:19], v[196:199], v[36:39]
  ds_read_b64_tr_b16 v[28:29], v5 offset:0
  s_add_u32 m0, s39, 0xa000
  s_add_u32 s45, s43, 409344
  buffer_load_dwordx4 v4, s[20:23], s45 offen  lds
  v_mfma_f32_16x16x32_bf16 v[40:43], v[16:19], v[200:203], v[40:43]
  ds_read_b64_tr_b16 v[30:31], v5 offset:2048
  s_add_u32 m0, s39, 0xb000
  s_add_u32 s45, s43, 450304
  buffer_load_dwordx4 v4, s[20:23], s45 offen  lds
  v_mfma_f32_16x16x32_bf16 v[48:51], v[20:23], v[192:195], v[48:51]
  ds_read_b64_tr_b16 v[16:17], v3 offset:4096
  s_add_u32 m0, s39, 0xc000
  s_add_u32 s45, s43, 369024
  buffer_load_dwordx4 v4, s[20:23], s45 offen  lds
  v_mfma_f32_16x16x32_bf16 v[52:55], v[20:23], v[196:199], v[52:55]
  ds_read_b64_tr_b16 v[18:19], v3 offset:6144
  s_add_u32 m0, s39, 0xd000
  s_add_u32 s45, s43, 409984
  buffer_load_dwordx4 v4, s[20:23], s45 offen  lds
  v_mfma_f32_16x16x32_bf16 v[56:59], v[20:23], v[200:203], v[56:59]
  s_add_u32 m0, s39, 0xe000
  s_add_u32 s45, s43, 450944
  buffer_load_dwordx4 v4, s[20:23], s45 offen  lds
  s_waitcnt lgkmcnt(4)
  v_mfma_f32_16x16x32_bf16 v[32:35], v[24:27], v[208:211], v[32:35]
  ds_read_b64_tr_b16 v[20:21], v5 offset:4096
  s_add_u32 m0, s39, 0xf000
  s_add_u32 s45, s43, -128
  buffer_load_dwordx4 v4, s[20:23], s45 offen  lds
  v_mfma_f32_16x16x32_bf16 v[36:39], v[24:27], v[212:215], v[36:39]
  ds_read_b64_tr_b16 v[22:23], v5 offset:6144
  v_mfma_f32_16x16x32_bf16 v[40:43], v[24:27], v[216:219], v[40:43]
  s_add_u32 m0, s39, 0x10000
  s_add_u32 s45, s43, 40832
  buffer_load_dwordx4 v4, s[20:23], s45 offen  lds
  s_waitcnt lgkmcnt(4)
  v_mfma_f32_16x16x32_bf16 v[48:51], v[28:31], v[208:211], v[48:51]
  ds_read_b64_tr_b16 v[24:25], v3 offset:8192
  v_mfma_f32_16x16x32_bf16 v[52:55], v[28:31], v[212:215], v[52:55]
  ds_read_b64_tr_b16 v[26:27], v3 offset:10240
  s_add_u32 m0, s39, 0x11000
  s_add_u32 s45, s43, 81792
  buffer_load_dwordx4 v4, s[20:23], s45 offen  lds
  v_mfma_f32_16x16x32_bf16 v[56:59], v[28:31], v[216:219], v[56:59]
  s_add_u32 m0, s39, 0x12000
  s_add_u32 s45, s43, 512
  buffer_load_dwordx4 v4, s[20:23], s45 offen  lds
  s_waitcnt lgkmcnt(4)
  v_mfma_f32_16x16x32_bf16 v[32:35], v[16:19], v[224:227], v[32:35]
  ds_read_b64_tr_b16 v[28:29], v5 offset:8192
  ds_read_b64_tr_b16 v[30:31], v5 offset:10240
  v_mfma_f32_16x16x32_bf16 v[36:39], v[16:19], v[228:231], v[36:39]
  v_add_u32 v3, 0, v2
  v_mfma_f32_16x16x32_bf16 v[40:43], v[16:19], v[232:235], v[40:43]
  v_xor_b32 v5, 32, v3
  s_add_u32 m0, s39, 0x13000
  s_add_u32 s45, s43, 41472
  buffer_load_dwordx4 v4, s[20:23], s45 offen  lds
  s_waitcnt lgkmcnt(4)
  v_mfma_f32_16x16x32_bf16 v[48:51], v[20:23], v[224:227], v[48:51]
  s_add_u32 m0, s39, 0x14000
  s_add_u32 s45, s43, 82432
  buffer_load_dwordx4 v4, s[20:23], s45 offen  lds
  v_mfma_f32_16x16x32_bf16 v[52:55], v[20:23], v[228:231], v[52:55]
  v_mfma_f32_16x16x32_bf16 v[56:59], v[20:23], v[232:235], v[56:59]
  s_waitcnt lgkmcnt(0)
  s_barrier
  v_mfma_f32_16x16x32_bf16 v[32:35], v[24:27], v[240:243], v[32:35]
  ds_read_b64_tr_b16 v[16:17], v3 offset:0
  ds_read_b64_tr_b16 v[18:19], v3 offset:2048
  v_mfma_f32_16x16x32_bf16 v[36:39], v[24:27], v[244:247], v[36:39]
  ds_read_b64_tr_b16 v[20:21], v5 offset:0
  v_mfma_f32_16x16x32_bf16 v[40:43], v[24:27], v[248:251], v[40:43]
  ds_read_b64_tr_b16 v[22:23], v5 offset:2048
  v_mfma_f32_16x16x32_bf16 v[48:51], v[28:31], v[240:243], v[48:51]
  ds_read_b64_tr_b16 v[24:25], v3 offset:4096
  v_mfma_f32_16x16x32_bf16 v[52:55], v[28:31], v[244:247], v[52:55]
  ds_read_b64_tr_b16 v[26:27], v3 offset:6144
  v_mfma_f32_16x16x32_bf16 v[56:59], v[28:31], v[248:251], v[56:59]
  s_waitcnt lgkmcnt(4)
  v_cvt_pk_bf16_f32 v8, v32, v33
  v_cvt_pk_bf16_f32 v9, v34, v35
  v_mfma_f32_16x16x32_bf16 v[32:35], v[16:19], v[64:67], 0
  ds_read_b64_tr_b16 v[28:29], v5 offset:4096
  v_cvt_pk_bf16_f32 v10, v36, v37
  v_cvt_pk_bf16_f32 v11, v38, v39
  v_mfma_f32_16x16x32_bf16 v[36:39], v[16:19], v[68:71], 0
  buffer_store_dwordx4 v[8:11], v6, s[24:27], s46 offen offset:0 sc1
  ds_read_b64_tr_b16 v[30:31], v5 offset:6144
  v_cvt_pk_bf16_f32 v12, v40, v41
  v_cvt_pk_bf16_f32 v13, v42, v43
  v_mfma_f32_16x16x32_bf16 v[40:43], v[16:19], v[72:75], 0
  buffer_store_dwordx2 v[12:13], v0, s[24:27], s76 offen offset:0 sc1
  s_waitcnt lgkmcnt(4)
  v_cvt_pk_bf16_f32 v8, v48, v49
  v_cvt_pk_bf16_f32 v9, v50, v51
  v_mfma_f32_16x16x32_bf16 v[48:51], v[20:23], v[64:67], 0
  ds_read_b64_tr_b16 v[16:17], v3 offset:8192
  v_cvt_pk_bf16_f32 v10, v52, v53
  v_cvt_pk_bf16_f32 v11, v54, v55
  v_mfma_f32_16x16x32_bf16 v[52:55], v[20:23], v[68:71], 0
  buffer_store_dwordx4 v[8:11], v6, s[24:27], s46 offen offset:1024 sc1
  ds_read_b64_tr_b16 v[18:19], v3 offset:10240
  v_cvt_pk_bf16_f32 v12, v56, v57
  v_cvt_pk_bf16_f32 v13, v58, v59
  v_mfma_f32_16x16x32_bf16 v[56:59], v[20:23], v[72:75], 0
  buffer_store_dwordx2 v[12:13], v0, s[24:27], s76 offen offset:512 sc1
  s_add_u32 s46, s46, 28672
  s_add_u32 s76, s76, 28672
  s_waitcnt lgkmcnt(4)
  v_mfma_f32_16x16x32_bf16 v[32:35], v[24:27], v[80:83], v[32:35]
  ds_read_b64_tr_b16 v[20:21], v5 offset:8192
  ds_read_b64_tr_b16 v[22:23], v5 offset:10240
  v_mfma_f32_16x16x32_bf16 v[36:39], v[24:27], v[84:87], v[36:39]
  v_add_u32 v3, 98304, v2
  v_mfma_f32_16x16x32_bf16 v[40:43], v[24:27], v[88:91], v[40:43]
  v_xor_b32 v5, 32, v3
  s_waitcnt lgkmcnt(4)
  v_mfma_f32_16x16x32_bf16 v[48:51], v[28:31], v[80:83], v[48:51]
  v_mfma_f32_16x16x32_bf16 v[52:55], v[28:31], v[84:87], v[52:55]
  v_mfma_f32_16x16x32_bf16 v[56:59], v[28:31], v[88:91], v[56:59]
  s_waitcnt vmcnt(22) lgkmcnt(0)
  s_barrier
  v_mfma_f32_16x16x32_bf16 v[32:35], v[16:19], v[96:99], v[32:35]
  ds_read_b64_tr_b16 v[24:25], v3 offset:0
  ds_read_b64_tr_b16 v[26:27], v3 offset:2048
  v_mfma_f32_16x16x32_bf16 v[36:39], v[16:19], v[100:103], v[36:39]
  ds_read_b64_tr_b16 v[28:29], v5 offset:0
  v_mfma_f32_16x16x32_bf16 v[40:43], v[16:19], v[104:107], v[40:43]
  ds_read_b64_tr_b16 v[30:31], v5 offset:2048
  v_mfma_f32_16x16x32_bf16 v[48:51], v[20:23], v[96:99], v[48:51]
  ds_read_b64_tr_b16 v[16:17], v3 offset:4096
  v_mfma_f32_16x16x32_bf16 v[52:55], v[20:23], v[100:103], v[52:55]
  ds_read_b64_tr_b16 v[18:19], v3 offset:6144
  v_mfma_f32_16x16x32_bf16 v[56:59], v[20:23], v[104:107], v[56:59]
  s_waitcnt lgkmcnt(4)
  v_mfma_f32_16x16x32_bf16 v[32:35], v[24:27], v[112:115], v[32:35]
  ds_read_b64_tr_b16 v[20:21], v5 offset:4096
  v_mfma_f32_16x16x32_bf16 v[36:39], v[24:27], v[116:119], v[36:39]
  ds_read_b64_tr_b16 v[22:23], v5 offset:6144
  v_mfma_f32_16x16x32_bf16 v[40:43], v[24:27], v[120:123], v[40:43]
  s_waitcnt lgkmcnt(4)
  v_mfma_f32_16x16x32_bf16 v[48:51], v[28:31], v[112:115], v[48:51]
  ds_read_b64_tr_b16 v[24:25], v3 offset:8192
  v_mfma_f32_16x16x32_bf16 v[52:55], v[28:31], v[116:119], v[52:55]
  ds_read_b64_tr_b16 v[26:27], v3 offset:10240
  v_mfma_f32_16x16x32_bf16 v[56:59], v[28:31], v[120:123], v[56:59]
  s_waitcnt lgkmcnt(4)
  v_mfma_f32_16x16x32_bf16 v[32:35], v[16:19], v[128:131], v[32:35]
  ds_read_b64_tr_b16 v[28:29], v5 offset:8192
  ds_read_b64_tr_b16 v[30:31], v5 offset:10240
  v_mfma_f32_16x16x32_bf16 v[36:39], v[16:19], v[132:135], v[36:39]
  v_add_u32 v3, 122880, v2
  v_mfma_f32_16x16x32_bf16 v[40:43], v[16:19], v[136:139], v[40:43]
  v_xor_b32 v5, 32, v3
  s_waitcnt lgkmcnt(4)
  v_mfma_f32_16x16x32_bf16 v[48:51], v[20:23], v[128:131], v[48:51]
  v_mfma_f32_16x16x32_bf16 v[52:55], v[20:23], v[132:135], v[52:55]
  v_mfma_f32_16x16x32_bf16 v[56:59], v[20:23], v[136:139], v[56:59]
  s_waitcnt vmcnt(16) lgkmcnt(0)
  s_barrier
  v_mfma_f32_16x16x32_bf16 v[32:35], v[24:27], v[144:147], v[32:35]
  ds_read_b64_tr_b16 v[16:17], v3 offset:0
  ds_read_b64_tr_b16 v[18:19], v3 offset:2048
  s_add_u32 m0, s39, 0x3000
  s_add_u32 s45, s43, 122752
  buffer_load_dwordx4 v4, s[20:23], s45 offen  lds
  v_mfma_f32_16x16x32_bf16 v[36:39], v[24:27], v[148:151], v[36:39]
  ds_read_b64_tr_b16 v[20:21], v5 offset:0
  s_add_u32 m0, s39, 0x4000
  s_add_u32 s45, s43, 163712
  buffer_load_dwordx4 v4, s[20:23], s45 offen  lds
  v_mfma_f32_16x16x32_bf16 v[40:43], v[24:27], v[152:155], v[40:43]
  ds_read_b64_tr_b16 v[22:23], v5 offset:2048
  s_add_u32 m0, s39, 0x5000
  s_add_u32 s45, s43, 204672
  buffer_load_dwordx4 v4, s[20:23], s45 offen  lds
  v_mfma_f32_16x16x32_bf16 v[48:51], v[28:31], v[144:147], v[48:51]
  ds_read_b64_tr_b16 v[24:25], v3 offset:4096
  s_add_u32 m0, s39, 0x6000
  s_add_u32 s45, s43, 123392
  buffer_load_dwordx4 v4, s[20:23], s45 offen  lds
  v_mfma_f32_16x16x32_bf16 v[52:55], v[28:31], v[148:151], v[52:55]
  ds_read_b64_tr_b16 v[26:27], v3 offset:6144
  s_add_u32 m0, s39, 0x7000
  s_add_u32 s45, s43, 164352
  buffer_load_dwordx4 v4, s[20:23], s45 offen  lds
  v_mfma_f32_16x16x32_bf16 v[56:59], v[28:31], v[152:155], v[56:59]
  s_add_u32 m0, s39, 0x8000
  s_add_u32 s45, s43, 205312
  buffer_load_dwordx4 v4, s[20:23], s45 offen  lds
  s_waitcnt lgkmcnt(4)
  v_mfma_f32_16x16x32_bf16 v[32:35], v[16:19], v[160:163], v[32:35]
  ds_read_b64_tr_b16 v[28:29], v5 offset:4096
  s_add_u32 m0, s39, 0xffffd000
  s_add_u32 s45, s43, 245632
  buffer_load_dwordx4 v4, s[20:23], s45 offen  lds
  v_mfma_f32_16x16x32_bf16 v[36:39], v[16:19], v[164:167], v[36:39]
  ds_read_b64_tr_b16 v[30:31], v5 offset:6144
  v_mfma_f32_16x16x32_bf16 v[40:43], v[16:19], v[168:171], v[40:43]
  s_add_u32 m0, s39, 0xffffe000
  s_add_u32 s45, s43, 286592
  buffer_load_dwordx4 v4, s[20:23], s45 offen  lds
  s_waitcnt lgkmcnt(4)
  v_mfma_f32_16x16x32_bf16 v[48:51], v[20:23], v[160:163], v[48:51]
  ds_read_b64_tr_b16 v[16:17], v3 offset:8192
  v_mfma_f32_16x16x32_bf16 v[52:55], v[20:23], v[164:167], v[52:55]
  ds_read_b64_tr_b16 v[18:19], v3 offset:10240
  s_add_u32 m0, s39, 0xfffff000
  s_add_u32 s45, s43, 327552
  buffer_load_dwordx4 v4, s[20:23], s45 offen  lds
  v_mfma_f32_16x16x32_bf16 v[56:59], v[20:23], v[168:171], v[56:59]
  s_add_u32 m0, s39, 0x0
  s_add_u32 s45, s43, 246272
  buffer_load_dwordx4 v4, s[20:23], s45 offen  lds
  s_waitcnt lgkmcnt(4)
  v_mfma_f32_16x16x32_bf16 v[32:35], v[24:27], v[176:179], v[32:35]
  ds_read_b64_tr_b16 v[20:21], v5 offset:8192
  ds_read_b64_tr_b16 v[22:23], v5 offset:10240
  v_mfma_f32_16x16x32_bf16 v[36:39], v[24:27], v[180:183], v[36:39]
  v_add_u32 v3, 49152, v2
  v_mfma_f32_16x16x32_bf16 v[40:43], v[24:27], v[184:187], v[40:43]
  v_xor_b32 v5, 32, v3
  s_add_u32 m0, s39, 0x1000
  s_add_u32 s45, s43, 287232
  buffer_load_dwordx4 v4, s[20:23], s45 offen  lds
  s_waitcnt lgkmcnt(4)
  v_mfma_f32_16x16x32_bf16 v[48:51], v[28:31], v[176:179], v[48:51]
  s_add_u32 m0, s39, 0x2000
  s_add_u32 s45, s43, 328192
  buffer_load_dwordx4 v4, s[20:23], s45 offen  lds
  v_mfma_f32_16x16x32_bf16 v[52:55], v[28:31], v[180:183], v[52:55]
  v_mfma_f32_16x16x32_bf16 v[56:59], v[28:31], v[184:187], v[56:59]
  s_waitcnt vmcnt(12) lgkmcnt(0)
  s_barrier
  v_mfma_f32_16x16x32_bf16 v[32:35], v[16:19], v[192:195], v[32:35]
  ds_read_b64_tr_b16 v[24:25], v3 offset:0
  ds_read_b64_tr_b16 v[26:27], v3 offset:2048
  v_mfma_f32_16x16x32_bf16 v[36:39], v[16:19], v[196:199], v[36:39]
  ds_read_b64_tr_b16 v[28:29], v5 offset:0
  v_mfma_f32_16x16x32_bf16 v[40:43], v[16:19], v[200:203], v[40:43]
  ds_read_b64_tr_b16 v[30:31], v5 offset:2048
  v_mfma_f32_16x16x32_bf16 v[48:51], v[20:23], v[192:195], v[48:51]
  ds_read_b64_tr_b16 v[16:17], v3 offset:4096
  v_mfma_f32_16x16x32_bf16 v[52:55], v[20:23], v[196:199], v[52:55]
  ds_read_b64_tr_b16 v[18:19], v3 offset:6144
  v_mfma_f32_16x16x32_bf16 v[56:59], v[20:23], v[200:203], v[56:59]
  s_add_u32 m0, s39, 0x15000
  s_add_u32 s45, s43, 368512
  buffer_load_dwordx4 v4, s[20:23], s45 offen  lds
  s_waitcnt lgkmcnt(4)
  v_mfma_f32_16x16x32_bf16 v[32:35], v[24:27], v[208:211], v[32:35]
  ds_read_b64_tr_b16 v[20:21], v5 offset:4096
  v_mfma_f32_16x16x32_bf16 v[36:39], v[24:27], v[212:215], v[36:39]
  ds_read_b64_tr_b16 v[22:23], v5 offset:6144
  v_mfma_f32_16x16x32_bf16 v[40:43], v[24:27], v[216:219], v[40:43]
  s_add_u32 m0, s39, 0x16000
  s_add_u32 s45, s43, 409472
  buffer_load_dwordx4 v4, s[20:23], s45 offen  lds
  s_waitcnt lgkmcnt(4)
  v_mfma_f32_16x16x32_bf16 v[48:51], v[28:31], v[208:211], v[48:51]
  ds_read_b64_tr_b16 v[24:25], v3 offset:8192
  v_mfma_f32_16x16x32_bf16 v[52:55], v[28:31], v[212:215], v[52:55]
  ds_read_b64_tr_b16 v[26:27], v3 offset:10240
  s_add_u32 m0, s39, 0x17000
  s_add_u32 s45, s43, 450432
  buffer_load_dwordx4 v4, s[20:23], s45 offen  lds
  v_mfma_f32_16x16x32_bf16 v[56:59], v[28:31], v[216:219], v[56:59]
  s_add_u32 m0, s39, 0x18000
  s_add_u32 s45, s43, 369152
  buffer_load_dwordx4 v4, s[20:23], s45 offen  lds
  s_waitcnt lgkmcnt(4)
  v_mfma_f32_16x16x32_bf16 v[32:35], v[16:19], v[224:227], v[32:35]
  ds_read_b64_tr_b16 v[28:29], v5 offset:8192
  ds_read_b64_tr_b16 v[30:31], v5 offset:10240
  v_mfma_f32_16x16x32_bf16 v[36:39], v[16:19], v[228:231], v[36:39]
  v_add_u32 v3, 73728, v2
  v_mfma_f32_16x16x32_bf16 v[40:43], v[16:19], v[232:235], v[40:43]
  v_xor_b32 v5, 32, v3
  s_add_u32 m0, s39, 0x19000
  s_add_u32 s45, s43, 410112
  buffer_load_dwordx4 v4, s[20:23], s45 offen  lds
  s_waitcnt lgkmcnt(4)
  v_mfma_f32_16x16x32_bf16 v[48:51], v[20:23], v[224:227], v[48:51]
  s_add_u32 m0, s39, 0x1a000
  s_add_u32 s45, s43, 451072
  buffer_load_dwordx4 v4, s[20:23], s45 offen  lds
  v_mfma_f32_16x16x32_bf16 v[52:55], v[20:23], v[228:231], v[52:55]
  v_mfma_f32_16x16x32_bf16 v[56:59], v[20:23], v[232:235], v[56:59]
  s_waitcnt lgkmcnt(0)
  s_barrier
  v_mfma_f32_16x16x32_bf16 v[32:35], v[24:27], v[240:243], v[32:35]
  ds_read_b64_tr_b16 v[16:17], v3 offset:0
  ds_read_b64_tr_b16 v[18:19], v3 offset:2048
  v_mfma_f32_16x16x32_bf16 v[36:39], v[24:27], v[244:247], v[36:39]
  ds_read_b64_tr_b16 v[20:21], v5 offset:0
  v_mfma_f32_16x16x32_bf16 v[40:43], v[24:27], v[248:251], v[40:43]
  ds_read_b64_tr_b16 v[22:23], v5 offset:2048
  v_mfma_f32_16x16x32_bf16 v[48:51], v[28:31], v[240:243], v[48:51]
  ds_read_b64_tr_b16 v[24:25], v3 offset:4096
  v_mfma_f32_16x16x32_bf16 v[52:55], v[28:31], v[244:247], v[52:55]
  ds_read_b64_tr_b16 v[26:27], v3 offset:6144
  v_mfma_f32_16x16x32_bf16 v[56:59], v[28:31], v[248:251], v[56:59]
  s_waitcnt lgkmcnt(4)
  v_cvt_pk_bf16_f32 v8, v32, v33
  v_cvt_pk_bf16_f32 v9, v34, v35
  v_mfma_f32_16x16x32_bf16 v[32:35], v[16:19], v[64:67], 0
  ds_read_b64_tr_b16 v[28:29], v5 offset:4096
  v_cvt_pk_bf16_f32 v10, v36, v37
  v_cvt_pk_bf16_f32 v11, v38, v39
  v_mfma_f32_16x16x32_bf16 v[36:39], v[16:19], v[68:71], 0
  buffer_store_dwordx4 v[8:11], v6, s[24:27], s46 offen offset:0 sc1
  ds_read_b64_tr_b16 v[30:31], v5 offset:6144
  v_cvt_pk_bf16_f32 v12, v40, v41
  v_cvt_pk_bf16_f32 v13, v42, v43
  v_mfma_f32_16x16x32_bf16 v[40:43], v[16:19], v[72:75], 0
  buffer_store_dwordx2 v[12:13], v0, s[24:27], s76 offen offset:0 sc1
  s_waitcnt lgkmcnt(4)
  v_cvt_pk_bf16_f32 v8, v48, v49
  v_cvt_pk_bf16_f32 v9, v50, v51
  v_mfma_f32_16x16x32_bf16 v[48:51], v[20:23], v[64:67], 0
  ds_read_b64_tr_b16 v[16:17], v3 offset:8192
  v_cvt_pk_bf16_f32 v10, v52, v53
  v_cvt_pk_bf16_f32 v11, v54, v55
  v_mfma_f32_16x16x32_bf16 v[52:55], v[20:23], v[68:71], 0
  buffer_store_dwordx4 v[8:11], v6, s[24:27], s46 offen offset:1024 sc1
  ds_read_b64_tr_b16 v[18:19], v3 offset:10240
  v_cvt_pk_bf16_f32 v12, v56, v57
  v_cvt_pk_bf16_f32 v13, v58, v59
  v_mfma_f32_16x16x32_bf16 v[56:59], v[20:23], v[72:75], 0
  buffer_store_dwordx2 v[12:13], v0, s[24:27], s76 offen offset:512 sc1
  s_add_u32 s46, s46, 28672
  s_add_u32 s76, s76, 28672
  s_waitcnt lgkmcnt(4)
  v_mfma_f32_16x16x32_bf16 v[32:35], v[24:27], v[80:83], v[32:35]
  ds_read_b64_tr_b16 v[20:21], v5 offset:8192
  ds_read_b64_tr_b16 v[22:23], v5 offset:10240
  v_mfma_f32_16x16x32_bf16 v[36:39], v[24:27], v[84:87], v[36:39]
  v_add_u32 v3, 24576, v2
  v_mfma_f32_16x16x32_bf16 v[40:43], v[24:27], v[88:91], v[40:43]
  v_xor_b32 v5, 32, v3
  s_waitcnt lgkmcnt(4)
  v_mfma_f32_16x16x32_bf16 v[48:51], v[28:31], v[80:83], v[48:51]
  v_mfma_f32_16x16x32_bf16 v[52:55], v[28:31], v[84:87], v[52:55]
  v_mfma_f32_16x16x32_bf16 v[56:59], v[28:31], v[88:91], v[56:59]
  s_waitcnt vmcnt(16) lgkmcnt(0)
  s_barrier
  v_mfma_f32_16x16x32_bf16 v[32:35], v[16:19], v[96:99], v[32:35]
  ds_read_b64_tr_b16 v[24:25], v3 offset:0
  ds_read_b64_tr_b16 v[26:27], v3 offset:2048
  v_mfma_f32_16x16x32_bf16 v[36:39], v[16:19], v[100:103], v[36:39]
  ds_read_b64_tr_b16 v[28:29], v5 offset:0
  v_mfma_f32_16x16x32_bf16 v[40:43], v[16:19], v[104:107], v[40:43]
  ds_read_b64_tr_b16 v[30:31], v5 offset:2048
  v_mfma_f32_16x16x32_bf16 v[48:51], v[20:23], v[96:99], v[48:51]
  ds_read_b64_tr_b16 v[16:17], v3 offset:4096
  v_mfma_f32_16x16x32_bf16 v[52:55], v[20:23], v[100:103], v[52:55]
  ds_read_b64_tr_b16 v[18:19], v3 offset:6144
  v_mfma_f32_16x16x32_bf16 v[56:59], v[20:23], v[104:107], v[56:59]
  s_waitcnt lgkmcnt(4)
  v_mfma_f32_16x16x32_bf16 v[32:35], v[24:27], v[112:115], v[32:35]
  ds_read_b64_tr_b16 v[20:21], v5 offset:4096
  v_mfma_f32_16x16x32_bf16 v[36:39], v[24:27], v[116:119], v[36:39]
  ds_read_b64_tr_b16 v[22:23], v5 offset:6144
  v_mfma_f32_16x16x32_bf16 v[40:43], v[24:27], v[120:123], v[40:43]
  s_waitcnt lgkmcnt(4)
  v_mfma_f32_16x16x32_bf16 v[48:51], v[28:31], v[112:115], v[48:51]
  ds_read_b64_tr_b16 v[24:25], v3 offset:8192
  v_mfma_f32_16x16x32_bf16 v[52:55], v[28:31], v[116:119], v[52:55]
  ds_read_b64_tr_b16 v[26:27], v3 offset:10240
  v_mfma_f32_16x16x32_bf16 v[56:59], v[28:31], v[120:123], v[56:59]
  s_waitcnt lgkmcnt(4)
  v_mfma_f32_16x16x32_bf16 v[32:35], v[16:19], v[128:131], v[32:35]
  ds_read_b64_tr_b16 v[28:29], v5 offset:8192
  ds_read_b64_tr_b16 v[30:31], v5 offset:10240
  v_mfma_f32_16x16x32_bf16 v[36:39], v[16:19], v[132:135], v[36:39]
  v_add_u32 v3, 0, v2
  v_mfma_f32_16x16x32_bf16 v[40:43], v[16:19], v[136:139], v[40:43]
  v_xor_b32 v5, 32, v3
  s_waitcnt lgkmcnt(4)
  v_mfma_f32_16x16x32_bf16 v[48:51], v[20:23], v[128:131], v[48:51]
  v_bfe_u32 v14, v0, 3, 4
  v_mul_lo_u32 v14, v14, s90
  buffer_load_dword v15, v14, s[24:27], s83 offen sc1
  v_mfma_f32_16x16x32_bf16 v[52:55], v[20:23], v[132:135], v[52:55]
  v_mfma_f32_16x16x32_bf16 v[56:59], v[20:23], v[136:139], v[56:59]
  s_waitcnt vmcnt(11) lgkmcnt(0)
  s_barrier
  v_mfma_f32_16x16x32_bf16 v[32:35], v[24:27], v[144:147], v[32:35]
  ds_read_b64_tr_b16 v[16:17], v3 offset:0
  ds_read_b64_tr_b16 v[18:19], v3 offset:2048
  v_mfma_f32_16x16x32_bf16 v[36:39], v[24:27], v[148:151], v[36:39]
  ds_read_b64_tr_b16 v[20:21], v5 offset:0
  v_mfma_f32_16x16x32_bf16 v[40:43], v[24:27], v[152:155], v[40:43]
  ds_read_b64_tr_b16 v[22:23], v5 offset:2048
  v_mfma_f32_16x16x32_bf16 v[48:51], v[28:31], v[144:147], v[48:51]
  ds_read_b64_tr_b16 v[24:25], v3 offset:4096
  v_mfma_f32_16x16x32_bf16 v[52:55], v[28:31], v[148:151], v[52:55]
  ds_read_b64_tr_b16 v[26:27], v3 offset:6144
  v_mfma_f32_16x16x32_bf16 v[56:59], v[28:31], v[152:155], v[56:59]
  s_waitcnt lgkmcnt(4)
  v_mfma_f32_16x16x32_bf16 v[32:35], v[16:19], v[160:163], v[32:35]
  ds_read_b64_tr_b16 v[28:29], v5 offset:4096
  v_mfma_f32_16x16x32_bf16 v[36:39], v[16:19], v[164:167], v[36:39]
  ds_read_b64_tr_b16 v[30:31], v5 offset:6144
  v_mfma_f32_16x16x32_bf16 v[40:43], v[16:19], v[168:171], v[40:43]
  s_waitcnt lgkmcnt(4)
  v_mfma_f32_16x16x32_bf16 v[48:51], v[20:23], v[160:163], v[48:51]
  ds_read_b64_tr_b16 v[16:17], v3 offset:8192
  v_mfma_f32_16x16x32_bf16 v[52:55], v[20:23], v[164:167], v[52:55]
  ds_read_b64_tr_b16 v[18:19], v3 offset:10240
  v_mfma_f32_16x16x32_bf16 v[56:59], v[20:23], v[168:171], v[56:59]
  s_waitcnt lgkmcnt(4)
  v_mfma_f32_16x16x32_bf16 v[32:35], v[24:27], v[176:179], v[32:35]
  ds_read_b64_tr_b16 v[20:21], v5 offset:8192
  ds_read_b64_tr_b16 v[22:23], v5 offset:10240
  v_mfma_f32_16x16x32_bf16 v[36:39], v[24:27], v[180:183], v[36:39]
  v_add_u32 v3, 98304, v2
  v_mfma_f32_16x16x32_bf16 v[40:43], v[24:27], v[184:187], v[40:43]
  v_xor_b32 v5, 32, v3
  s_waitcnt lgkmcnt(4)
  v_mfma_f32_16x16x32_bf16 v[48:51], v[28:31], v[176:179], v[48:51]
  v_mfma_f32_16x16x32_bf16 v[52:55], v[28:31], v[180:183], v[52:55]
  v_mfma_f32_16x16x32_bf16 v[56:59], v[28:31], v[184:187], v[56:59]
  s_waitcnt vmcnt(0) lgkmcnt(0)
  s_barrier
  v_mfma_f32_16x16x32_bf16 v[32:35], v[16:19], v[192:195], v[32:35]
  ds_read_b64_tr_b16 v[24:25], v3 offset:0
  ds_read_b64_tr_b16 v[26:27], v3 offset:2048
  v_mfma_f32_16x16x32_bf16 v[36:39], v[16:19], v[196:199], v[36:39]
  ds_read_b64_tr_b16 v[28:29], v5 offset:0
  v_mfma_f32_16x16x32_bf16 v[40:43], v[16:19], v[200:203], v[40:43]
  ds_read_b64_tr_b16 v[30:31], v5 offset:2048
  v_mfma_f32_16x16x32_bf16 v[48:51], v[20:23], v[192:195], v[48:51]
  ds_read_b64_tr_b16 v[16:17], v3 offset:4096
  v_mfma_f32_16x16x32_bf16 v[52:55], v[20:23], v[196:199], v[52:55]
  ds_read_b64_tr_b16 v[18:19], v3 offset:6144
  v_mfma_f32_16x16x32_bf16 v[56:59], v[20:23], v[200:203], v[56:59]
  v_cmp_ne_u32 vcc, s80, v15
  s_waitcnt lgkmcnt(4)
  v_mfma_f32_16x16x32_bf16 v[32:35], v[24:27], v[208:211], v[32:35]
  ds_read_b64_tr_b16 v[20:21], v5 offset:4096
  v_mfma_f32_16x16x32_bf16 v[36:39], v[24:27], v[212:215], v[36:39]
  ds_read_b64_tr_b16 v[22:23], v5 offset:6144
  v_mfma_f32_16x16x32_bf16 v[40:43], v[24:27], v[216:219], v[40:43]
  s_cmp_eq_u64 vcc, 0
  s_cselect_b32 s84, 1, 0
  s_waitcnt lgkmcnt(4)
  v_mfma_f32_16x16x32_bf16 v[48:51], v[28:31], v[208:211], v[48:51]
  ds_read_b64_tr_b16 v[24:25], v3 offset:8192
  v_mfma_f32_16x16x32_bf16 v[52:55], v[28:31], v[212:215], v[52:55]
  ds_read_b64_tr_b16 v[26:27], v3 offset:10240
  v_mfma_f32_16x16x32_bf16 v[56:59], v[28:31], v[216:219], v[56:59]
  s_waitcnt lgkmcnt(4)
  v_mfma_f32_16x16x32_bf16 v[32:35], v[16:19], v[224:227], v[32:35]
  ds_read_b64_tr_b16 v[28:29], v5 offset:8192
  v_mfma_f32_16x16x32_bf16 v[36:39], v[16:19], v[228:231], v[36:39]
  ds_read_b64_tr_b16 v[30:31], v5 offset:10240
  v_mfma_f32_16x16x32_bf16 v[40:43], v[16:19], v[232:235], v[40:43]
  s_waitcnt lgkmcnt(4)
  v_mfma_f32_16x16x32_bf16 v[48:51], v[20:23], v[224:227], v[48:51]
  v_mfma_f32_16x16x32_bf16 v[52:55], v[20:23], v[228:231], v[52:55]
  v_mfma_f32_16x16x32_bf16 v[56:59], v[20:23], v[232:235], v[56:59]
  s_waitcnt lgkmcnt(2)
  v_mfma_f32_16x16x32_bf16 v[32:35], v[24:27], v[240:243], v[32:35]
  v_mfma_f32_16x16x32_bf16 v[36:39], v[24:27], v[244:247], v[36:39]
  v_mfma_f32_16x16x32_bf16 v[40:43], v[24:27], v[248:251], v[40:43]
  s_waitcnt lgkmcnt(0)
  v_mfma_f32_16x16x32_bf16 v[48:51], v[28:31], v[240:243], v[48:51]
  v_mfma_f32_16x16x32_bf16 v[52:55], v[28:31], v[244:247], v[52:55]
  v_mfma_f32_16x16x32_bf16 v[56:59], v[28:31], v[248:251], v[56:59]
  s_nop 1
  v_cvt_pk_bf16_f32 v8, v32, v33
  v_cvt_pk_bf16_f32 v9, v34, v35
  v_cvt_pk_bf16_f32 v10, v36, v37
  v_cvt_pk_bf16_f32 v11, v38, v39
  buffer_store_dwordx4 v[8:11], v6, s[24:27], s46 offen offset:0 sc1
  v_cvt_pk_bf16_f32 v12, v40, v41
  v_cvt_pk_bf16_f32 v13, v42, v43
  buffer_store_dwordx2 v[12:13], v0, s[24:27], s76 offen offset:0 sc1
  v_cvt_pk_bf16_f32 v8, v48, v49
  v_cvt_pk_bf16_f32 v9, v50, v51
  v_cvt_pk_bf16_f32 v10, v52, v53
  v_cvt_pk_bf16_f32 v11, v54, v55
  buffer_store_dwordx4 v[8:11], v6, s[24:27], s46 offen offset:1024 sc1
  v_cvt_pk_bf16_f32 v12, v56, v57
  v_cvt_pk_bf16_f32 v13, v58, v59
  buffer_store_dwordx2 v[12:13], v0, s[24:27], s76 offen offset:512 sc1
  s_add_u32 s46, s46, 28672
  s_add_u32 s76, s76, 28672
L_fin:
  v_lshrrev_b32 v16, 3, v0
  v_add_u32 v17, s92, v16
  v_cmp_le_u32 s[60:61], s91, v16
  v_cmp_le_u32 vcc, 0x400, v17
  v_lshlrev_b32 v2, 4, v16
  v_lshrrev_b32 v18, 7, v17
  v_bfe_u32 v19, v17, 6, 3
  v_bfe_u32 v20, v17, 6, 1
  v_lshlrev_b32 v20, 5, v20
  v_mov_b32 v21, 64
  v_cndmask_b32 v18, v18, v19, vcc
  v_cndmask_b32 v20, v20, v21, vcc
  v_cmp_le_u32 vcc, 0x600, v17
  v_and_b32 v22, 63, v17
  v_bfe_u32 v19, v17, 5, 3
  v_mov_b32 v21, 0x60
  v_and_b32 v23, 31, v17
  v_lshlrev_b32 v23, 1, v23
  v_cndmask_b32 v18, v18, v19, vcc
  v_cndmask_b32 v20, v20, v21, vcc
  v_cndmask_b32 v22, v22, v23, vcc
  v_mov_b32 v19, 20480
  v_mov_b32 v21, 1280
  v_cndmask_b32 v19, v19, v21, vcc
  v_and_b32 v21, 15, v22
  v_add_u32 v20, v20, v21
  v_mul_u32_u24 v3, 1280, v20
  v_lshrrev_b32 v21, 4, v22
  v_lshl_add_u32 v3, v21, 3, v3
  v_and_b32 v21, 3, v18
  v_lshl_add_u32 v3, v21, 5, v3
  v_lshrrev_b32 v21, 2, v18
  v_mul_u32_u24 v21, 640, v21
  v_add_u32 v3, v3, v21
  v_add_u32 v4, v3, v19
  v_mov_b32 v21, 0x40000000
  v_cndmask_b32 v2, v2, v21, s[60:61]
  v_cndmask_b32 v3, v3, v21, s[60:61]
  v_cndmask_b32 v4, v4, v21, s[60:61]
  v_and_b32 v5, 15, v16
  v_mul_lo_u32 v5, v5, s90
  v_mov_b32 v6, s80
  v_lshrrev_b32 v14, 1, v0
  v_and_b32 v14, 124, v14
  s_lshr_b32 s40, s28, 1
  s_mov_b32 s62, 0xffff0000
  s_mov_b32 s46, s89
  s_cmp_lg_u32 s84, 1
  s_cbranch_scc1 L_nopre
  buffer_load_dwordx4 v[64:67], v2, s[24:27], s46 offen sc1
  s_add_u32 s46, s46, 144000
  buffer_load_dwordx4 v[68:71], v2, s[24:27], s46 offen sc1
  s_add_u32 s46, s46, 144000
  buffer_load_dwordx4 v[72:75], v2, s[24:27], s46 offen sc1
  s_add_u32 s46, s46, 144000
  buffer_load_dwordx4 v[76:79], v2, s[24:27], s46 offen sc1
  s_add_u32 s46, s46, 144000
  buffer_load_dwordx4 v[80:83], v2, s[24:27], s46 offen sc1
  s_add_u32 s46, s46, 144000
  buffer_load_dwordx4 v[84:87], v2, s[24:27], s46 offen sc1
  s_add_u32 s46, s46, 144000
  buffer_load_dwordx4 v[88:91], v2, s[24:27], s46 offen sc1
  s_add_u32 s46, s46, 144000
  buffer_load_dwordx4 v[92:95], v2, s[24:27], s46 offen sc1
  s_add_u32 s46, s46, 144000
  s_waitcnt vmcnt(8)
  s_branch L_drained
L_nopre:
  s_waitcnt vmcnt(0)
L_drained:
  s_barrier
  s_cmp_lg_u32 s28, 3
  s_cbranch_scc1 L_sigz
  v_mov_b32 v12, s80
  s_mov_b64 exec, 255
  buffer_store_dwordx4 v[12:15], v2, s[24:27], s85 offen offset:512 sc1
  s_mov_b64 exec, -1
L_sigz:
  s_cmp_eq_u32 s84, 2
  s_cbranch_scc1 L_sum
  s_cmp_eq_u32 s84, 1
  s_cbranch_scc1 L_rest
  s_mov_b32 s78, 0
L_poll:
  buffer_load_dword v7, v5, s[24:27], s83 offen sc1
  s_add_u32 s78, s78, 1
L_poll_chk:
  s_waitcnt vmcnt(0)
  v_cmp_ne_u32 vcc, s80, v7
  s_cbranch_vccz L_poll_ok
  s_sleep 4
  s_cmp_lt_u32 s78, 0x100000
  s_cbranch_scc1 L_poll
L_poll_ok:
L_all:
  buffer_load_dwordx4 v[64:67], v2, s[24:27], s46 offen sc1
  s_add_u32 s46, s46, 144000
  buffer_load_dwordx4 v[68:71], v2, s[24:27], s46 offen sc1
  s_add_u32 s46, s46, 144000
  buffer_load_dwordx4 v[72:75], v2, s[24:27], s46 offen sc1
  s_add_u32 s46, s46, 144000
  buffer_load_dwordx4 v[76:79], v2, s[24:27], s46 offen sc1
  s_add_u32 s46, s46, 144000
  buffer_load_dwordx4 v[80:83], v2, s[24:27], s46 offen sc1
  s_add_u32 s46, s46, 144000
  buffer_load_dwordx4 v[84:87], v2, s[24:27], s46 offen sc1
  s_add_u32 s46, s46, 144000
  buffer_load_dwordx4 v[88:91], v2, s[24:27], s46 offen sc1
  s_add_u32 s46, s46, 144000
  buffer_load_dwordx4 v[92:95], v2, s[24:27], s46 offen sc1
  s_add_u32 s46, s46, 144000
L_rest:
  buffer_load_dwordx4 v[96:99], v2, s[24:27], s46 offen sc1
  s_add_u32 s46, s46, 144000
  buffer_load_dwordx4 v[100:103], v2, s[24:27], s46 offen sc1
  s_add_u32 s46, s46, 144000
  buffer_load_dwordx4 v[104:107], v2, s[24:27], s46 offen sc1
  s_add_u32 s46, s46, 144000
  buffer_load_dwordx4 v[108:111], v2, s[24:27], s46 offen sc1
  s_add_u32 s46, s46, 144000
  buffer_load_dwordx4 v[112:115], v2, s[24:27], s46 offen sc1
  s_add_u32 s46, s46, 144000
  buffer_load_dwordx4 v[116:119], v2, s[24:27], s46 offen sc1
  s_add_u32 s46, s46, 144000
  buffer_load_dwordx4 v[120:123], v2, s[24:27], s46 offen sc1
  s_add_u32 s46, s46, 144000
  buffer_load_dwordx4 v[124:127], v2, s[24:27], s46 offen sc1
L_sum:
  s_lshl_b32 s47, s40, 7
  s_add_u32 s76, s38, s47
  s_cmp_lg_u32 s40, 0
  s_cbranch_scc1 L_nop4
  s_add_u32 s83, s79, 512
  buffer_load_dword v7, v5, s[24:27], s83 offen sc1
L_nop4:
  s_waitcnt vmcnt(15)
  v_lshlrev_b32 v32, 16, v64
  v_and_b32 v33, s62, v64
  v_lshlrev_b32 v34, 16, v65
  v_and_b32 v35, s62, v65
  v_lshlrev_b32 v36, 16, v66
  v_and_b32 v37, s62, v66
  v_lshlrev_b32 v38, 16, v67
  v_and_b32 v39, s62, v67
  s_waitcnt vmcnt(14)
  v_lshlrev_b32 v40, 16, v68
  v_and_b32 v41, s62, v68
  v_add_f32 v32, v32, v40
  v_add_f32 v33, v33, v41
  v_lshlrev_b32 v40, 16, v69
  v_and_b32 v41, s62, v69
  v_add_f32 v34, v34, v40
  v_add_f32 v35, v35, v41
  v_lshlrev_b32 v40, 16, v70
  v_and_b32 v41, s62, v70
  v_add_f32 v36, v36, v40
  v_add_f32 v37, v37, v41
  v_lshlrev_b32 v40, 16, v71
  v_and_b32 v41, s62, v71
  v_add_f32 v38, v38, v40
  v_add_f32 v39, v39, v41
  s_waitcnt vmcnt(13)
  v_lshlrev_b32 v40, 16, v72
  v_and_b32 v41, s62, v72
  v_add_f32 v32, v32, v40
  v_add_f32 v33, v33, v41
  v_lshlrev_b32 v40, 16, v73
  v_and_b32 v41, s62, v73
  v_add_f32 v34, v34, v40
  v_add_f32 v35, v35, v41
  v_lshlrev_b32 v40, 16, v74
  v_and_b32 v41, s62, v74
  v_add_f32 v36, v36, v40
  v_add_f32 v37, v37, v41
  v_lshlrev_b32 v40, 16, v75
  v_and_b32 v41, s62, v75
  v_add_f32 v38, v38, v40
  v_add_f32 v39, v39, v41
  s_waitcnt vmcnt(12)
  v_lshlrev_b32 v40, 16, v76
  v_and_b32 v41, s62, v76
  v_add_f32 v32, v32, v40
  v_add_f32 v33, v33, v41
  v_lshlrev_b32 v40, 16, v77
  v_and_b32 v41, s62, v77
  v_add_f32 v34, v34, v40
  v_add_f32 v35, v35, v41
  v_lshlrev_b32 v40, 16, v78
  v_and_b32 v41, s62, v78
  v_add_f32 v36, v36, v40
  v_add_f32 v37, v37, v41
  v_lshlrev_b32 v40, 16, v79
  v_and_b32 v41, s62, v79
  v_add_f32 v38, v38, v40
  v_add_f32 v39, v39, v41
  s_waitcnt vmcnt(11)
  v_lshlrev_b32 v40, 16, v80
  v_and_b32 v41, s62, v80
  v_add_f32 v32, v32, v40
  v_add_f32 v33, v33, v41
  v_lshlrev_b32 v40, 16, v81
  v_and_b32 v41, s62, v81
  v_add_f32 v34, v34, v40
  v_add_f32 v35, v35, v41
  v_lshlrev_b32 v40, 16, v82
  v_and_b32 v41, s62, v82
  v_add_f32 v36, v36, v40
  v_add_f32 v37, v37, v41
  v_lshlrev_b32 v40, 16, v83
  v_and_b32 v41, s62, v83
  v_add_f32 v38, v38, v40
  v_add_f32 v39, v39, v41
  s_waitcnt vmcnt(10)
  v_lshlrev_b32 v40, 16, v84
  v_and_b32 v41, s62, v84
  v_add_f32 v32, v32, v40
  v_add_f32 v33, v33, v41
  v_lshlrev_b32 v40, 16, v85
  v_and_b32 v41, s62, v85
  v_add_f32 v34, v34, v40
  v_add_f32 v35, v35, v41
  v_lshlrev_b32 v40, 16, v86
  v_and_b32 v41, s62, v86
  v_add_f32 v36, v36, v40
  v_add_f32 v37, v37, v41
  v_lshlrev_b32 v40, 16, v87
  v_and_b32 v41, s62, v87
  v_add_f32 v38, v38, v40
  v_add_f32 v39, v39, v41
  s_waitcnt vmcnt(9)
  v_lshlrev_b32 v40, 16, v88
  v_and_b32 v41, s62, v88
  v_add_f32 v32, v32, v40
  v_add_f32 v33, v33, v41
  v_lshlrev_b32 v40, 16, v89
  v_and_b32 v41, s62, v89
  v_add_f32 v34, v34, v40
  v_add_f32 v35, v35, v41
  v_lshlrev_b32 v40, 16, v90
  v_and_b32 v41, s62, v90
  v_add_f32 v36, v36, v40
  v_add_f32 v37, v37, v41
  v_lshlrev_b32 v40, 16, v91
  v_and_b32 v41, s62, v91
  v_add_f32 v38, v38, v40
  v_add_f32 v39, v39, v41
  s_waitcnt vmcnt(8)
  v_lshlrev_b32 v40, 16, v92
  v_and_b32 v41, s62, v92
  v_add_f32 v32, v32, v40
  v_add_f32 v33, v33, v41
  v_lshlrev_b32 v40, 16, v93
  v_and_b32 v41, s62, v93
  v_add_f32 v34, v34, v40
  v_add_f32 v35, v35, v41
  v_lshlrev_b32 v40, 16, v94
  v_and_b32 v41, s62, v94
  v_add_f32 v36, v36, v40
  v_add_f32 v37, v37, v41
  v_lshlrev_b32 v40, 16, v95
  v_and_b32 v41, s62, v95
  v_add_f32 v38, v38, v40
  v_add_f32 v39, v39, v41
  s_waitcnt vmcnt(7)
  v_lshlrev_b32 v40, 16, v96
  v_and_b32 v41, s62, v96
  v_add_f32 v32, v32, v40
  v_add_f32 v33, v33, v41
  v_lshlrev_b32 v40, 16, v97
  v_and_b32 v41, s62, v97
  v_add_f32 v34, v34, v40
  v_add_f32 v35, v35, v41
  v_lshlrev_b32 v40, 16, v98
  v_and_b32 v41, s62, v98
  v_add_f32 v36, v36, v40
  v_add_f32 v37, v37, v41
  v_lshlrev_b32 v40, 16, v99
  v_and_b32 v41, s62, v99
  v_add_f32 v38, v38, v40
  v_add_f32 v39, v39, v41
  s_waitcnt vmcnt(6)
  v_lshlrev_b32 v40, 16, v100
  v_and_b32 v41, s62, v100
  v_add_f32 v32, v32, v40
  v_add_f32 v33, v33, v41
  v_lshlrev_b32 v40, 16, v101
  v_and_b32 v41, s62, v101
  v_add_f32 v34, v34, v40
  v_add_f32 v35, v35, v41
  v_lshlrev_b32 v40, 16, v102
  v_and_b32 v41, s62, v102
  v_add_f32 v36, v36, v40
  v_add_f32 v37, v37, v41
  v_lshlrev_b32 v40, 16, v103
  v_and_b32 v41, s62, v103
  v_add_f32 v38, v38, v40
  v_add_f32 v39, v39, v41
  s_waitcnt vmcnt(5)
  v_lshlrev_b32 v40, 16, v104
  v_and_b32 v41, s62, v104
  v_add_f32 v32, v32, v40
  v_add_f32 v33, v33, v41
  v_lshlrev_b32 v40, 16, v105
  v_and_b32 v41, s62, v105
  v_add_f32 v34, v34, v40
  v_add_f32 v35, v35, v41
  v_lshlrev_b32 v40, 16, v106
  v_and_b32 v41, s62, v106
  v_add_f32 v36, v36, v40
  v_add_f32 v37, v37, v41
  v_lshlrev_b32 v40, 16, v107
  v_and_b32 v41, s62, v107
  v_add_f32 v38, v38, v40
  v_add_f32 v39, v39, v41
  s_waitcnt vmcnt(4)
  v_lshlrev_b32 v40, 16, v108
  v_and_b32 v41, s62, v108
  v_add_f32 v32, v32, v40
  v_add_f32 v33, v33, v41
  v_lshlrev_b32 v40, 16, v109
  v_and_b32 v41, s62, v109
  v_add_f32 v34, v34, v40
  v_add_f32 v35, v35, v41
  v_lshlrev_b32 v40, 16, v110
  v_and_b32 v41, s62, v110
  v_add_f32 v36, v36, v40
  v_add_f32 v37, v37, v41
  v_lshlrev_b32 v40, 16, v111
  v_and_b32 v41, s62, v111
  v_add_f32 v38, v38, v40
  v_add_f32 v39, v39, v41
  s_waitcnt vmcnt(3)
  v_lshlrev_b32 v40, 16, v112
  v_and_b32 v41, s62, v112
  v_add_f32 v32, v32, v40
  v_add_f32 v33, v33, v41
  v_lshlrev_b32 v40, 16, v113
  v_and_b32 v41, s62, v113
  v_add_f32 v34, v34, v40
  v_add_f32 v35, v35, v41
  v_lshlrev_b32 v40, 16, v114
  v_and_b32 v41, s62, v114
  v_add_f32 v36, v36, v40
  v_add_f32 v37, v37, v41
  v_lshlrev_b32 v40, 16, v115
  v_and_b32 v41, s62, v115
  v_add_f32 v38, v38, v40
  v_add_f32 v39, v39, v41
  s_waitcnt vmcnt(2)
  v_lshlrev_b32 v40, 16, v116
  v_and_b32 v41, s62, v116
  v_add_f32 v32, v32, v40
  v_add_f32 v33, v33, v41
  v_lshlrev_b32 v40, 16, v117
  v_and_b32 v41, s62, v117
  v_add_f32 v34, v34, v40
  v_add_f32 v35, v35, v41
  v_lshlrev_b32 v40, 16, v118
  v_and_b32 v41, s62, v118
  v_add_f32 v36, v36, v40
  v_add_f32 v37, v37, v41
  v_lshlrev_b32 v40, 16, v119
  v_and_b32 v41, s62, v119
  v_add_f32 v38, v38, v40
  v_add_f32 v39, v39, v41
  s_waitcnt vmcnt(1)
  v_lshlrev_b32 v40, 16, v120
  v_and_b32 v41, s62, v120
  v_add_f32 v32, v32, v40
  v_add_f32 v33, v33, v41
  v_lshlrev_b32 v40, 16, v121
  v_and_b32 v41, s62, v121
  v_add_f32 v34, v34, v40
  v_add_f32 v35, v35, v41
  v_lshlrev_b32 v40, 16, v122
  v_and_b32 v41, s62, v122
  v_add_f32 v36, v36, v40
  v_add_f32 v37, v37, v41
  v_lshlrev_b32 v40, 16, v123
  v_and_b32 v41, s62, v123
  v_add_f32 v38, v38, v40
  v_add_f32 v39, v39, v41
  s_waitcnt vmcnt(0)
  v_lshlrev_b32 v40, 16, v124
  v_and_b32 v41, s62, v124
  v_add_f32 v32, v32, v40
  v_add_f32 v33, v33, v41
  v_lshlrev_b32 v40, 16, v125
  v_and_b32 v41, s62, v125
  v_add_f32 v34, v34, v40
  v_add_f32 v35, v35, v41
  v_lshlrev_b32 v40, 16, v126
  v_and_b32 v41, s62, v126
  v_add_f32 v36, v36, v40
  v_add_f32 v37, v37, v41
  v_lshlrev_b32 v40, 16, v127
  v_and_b32 v41, s62, v127
  v_add_f32 v38, v38, v40
  v_add_f32 v39, v39, v41
  v_cvt_pk_bf16_f32 v44, v32, v33
  v_cvt_pk_bf16_f32 v45, v34, v35
  v_cvt_pk_bf16_f32 v46, v36, v37
  v_cvt_pk_bf16_f32 v47, v38, v39
  s_cmp_eq_u32 s40, 0
  s_cbranch_scc1 L_second
  buffer_store_dwordx2 v[44:45], v3, s[68:71], s76 offen
  buffer_store_dwordx2 v[46:47], v4, s[68:71], s76 offen
  s_branch L_done
L_second:
  s_mov_b32 s78, 0
  s_branch L_poll4_chk
L_poll4:
  buffer_load_dword v7, v5, s[24:27], s83 offen sc1
  s_add_u32 s78, s78, 1
L_poll4_chk:
  s_waitcnt vmcnt(0)
  v_cmp_ne_u32 vcc, s80, v7
  s_cbranch_vccz L_poll4_ok
  s_sleep 4
  s_cmp_lt_u32 s78, 0x100000
  s_cbranch_scc1 L_poll4
L_poll4_ok:
  buffer_store_dwordx2 v[44:45], v3, s[68:71], s76 offen
  buffer_store_dwordx2 v[46:47], v4, s[68:71], s76 offen
  s_mov_b32 s40, 4
  s_add_u32 s46, s88, 114688
  s_branch L_all
L_done:
L_end:
  s_endpgm
L_ika0_alt:
  s_cmp_lt_u32 s41, 14
  s_cbranch_scc1 L_ika0_ret
  s_mov_b32 m0, s34
  s_nop 0
  buffer_load_dwordx4 v3, s[12:15], s56 offen nt lds
  s_branch L_ika0_ret
L_ika1_alt:
  s_cmp_lt_u32 s41, 14
  s_cbranch_scc1 L_ika1_ret
  s_add_u32 m0, s34, 896
  s_nop 0
  buffer_load_dwordx4 v3, s[12:15], s56 offen offset:128 nt lds
  s_branch L_ika1_ret
L_ika2_alt:
  s_cmp_lt_u32 s41, 14
  s_cbranch_scc1 L_ika2_ret
  s_add_u32 m0, s34, 1792
  s_nop 0
  buffer_load_dwordx4 v3, s[12:15], s56 offen offset:256 nt lds
  s_add_u32 s56, s56, 12288
  s_add_u32 s34, s34, 24576
  s_cmp_eq_u32 s34, s58
  s_cselect_b32 s34, s33, s34
  s_branch L_ika2_ret
L_non:
  v_mov_b32 v27, 0
  buffer_load_dword v28, v27, s[72:75], s77 offen sc1
  s_branch L_non_ret
L_iva0_alt:
  s_cmp_lt_u32 s41, 14
  s_cbranch_scc1 L_iva0_ret
  s_add_u32 m0, s39, 49152
  s_add_u32 s45, s43, 0
  buffer_load_dwordx4 v4, s[20:23], s45 offen  lds
  s_branch L_iva0_ret
L_iva1_alt:
  s_cmp_lt_u32 s41, 14
  s_cbranch_scc1 L_iva1_ret
  s_add_u32 m0, s39, 53248
  s_add_u32 s45, s43, 40960
  buffer_load_dwordx4 v4, s[20:23], s45 offen  lds
  s_branch L_iva1_ret
L_iva2_alt:
  s_cmp_lt_u32 s41, 14
  s_cbranch_scc1 L_iva2_ret
  s_add_u32 m0, s39, 57344
  s_add_u32 s45, s43, 81920
  buffer_load_dwordx4 v4, s[20:23], s45 offen  lds
  s_branch L_iva2_ret
L_rare1a:
  v_mov_b32 v25, v23
  s_nop 1
  v_permlane32_swap_b32 v23, v25
  v_max_f32 v23, v23, v25
  v_mov_b32 v25, v23
  s_nop 1
  v_permlane16_swap_b32 v23, v25
  v_max_f32 v23, v23, v25
  v_max_f32 v23, 0, v23
  v_exp_f32 v21, -v23
  v_sub_f32 v248, v248, v23
  v_sub_f32 v249, v249, v23
  v_sub_f32 v250, v250, v23
  v_sub_f32 v251, v251, v23
  v_sub_f32 v56, v56, v23
  v_sub_f32 v57, v57, v23
  v_sub_f32 v58, v58, v23
  v_sub_f32 v59, v59, v23
  v_sub_f32 v60, v60, v23
  v_sub_f32 v61, v61, v23
  v_sub_f32 v62, v62, v23
  v_sub_f32 v63, v63, v23
  v_mov_b32 v25, v24
  s_nop 1
  v_permlane32_swap_b32 v24, v25
  v_max_f32 v24, v24, v25
  v_mov_b32 v25, v24
  s_nop 1
  v_permlane16_swap_b32 v24, v25
  v_max_f32 v24, v24, v25
  v_max_f32 v24, 0, v24
  v_exp_f32 v22, -v24
  v_sub_f32 v252, v252, v24
  v_sub_f32 v253, v253, v24
  v_sub_f32 v254, v254, v24
  v_sub_f32 v255, v255, v24
  v_sub_f32 v64, v64, v24
  v_sub_f32 v65, v65, v24
  v_sub_f32 v66, v66, v24
  v_sub_f32 v67, v67, v24
  v_sub_f32 v68, v68, v24
  v_sub_f32 v69, v69, v24
  v_sub_f32 v70, v70, v24
  v_sub_f32 v71, v71, v24
  s_mov_b32 s57, 1
  s_branch L_rare1a_ret
L_rare2a:
  s_nop 7
  v_mul_f32 v128, v128, v21
  v_mul_f32 v129, v129, v21
  v_mul_f32 v130, v130, v21
  v_mul_f32 v131, v131, v21
  v_mul_f32 v136, v136, v21
  v_mul_f32 v137, v137, v21
  v_mul_f32 v138, v138, v21
  v_mul_f32 v139, v139, v21
  v_mul_f32 v144, v144, v21
  v_mul_f32 v145, v145, v21
  v_mul_f32 v146, v146, v21
  v_mul_f32 v147, v147, v21
  v_mul_f32 v152, v152, v21
  v_mul_f32 v153, v153, v21
  v_mul_f32 v154, v154, v21
  v_mul_f32 v155, v155, v21
  v_mul_f32 v160, v160, v21
  v_mul_f32 v161, v161, v21
  v_mul_f32 v162, v162, v21
  v_mul_f32 v163, v163, v21
  v_mul_f32 v168, v168, v21
  v_mul_f32 v169, v169, v21
  v_mul_f32 v170, v170, v21
  v_mul_f32 v171, v171, v21
  v_mul_f32 v176, v176, v21
  v_mul_f32 v177, v177, v21
  v_mul_f32 v178, v178, v21
  v_mul_f32 v179, v179, v21
  v_mul_f32 v184, v184, v21
  v_mul_f32 v185, v185, v21
  v_mul_f32 v186, v186, v21
  v_mul_f32 v187, v187, v21
  v_mul_f32 v192, v192, v21
  v_mul_f32 v193, v193, v21
  v_mul_f32 v194, v194, v21
  v_mul_f32 v195, v195, v21
  v_mul_f32 v200, v200, v21
  v_mul_f32 v201, v201, v21
  v_mul_f32 v202, v202, v21
  v_mul_f32 v203, v203, v21
  v_mul_f32 v208, v208, v21
  v_mul_f32 v209, v209, v21
  v_mul_f32 v210, v210, v21
  v_mul_f32 v211, v211, v21
  v_mul_f32 v216, v216, v21
  v_mul_f32 v217, v217, v21
  v_mul_f32 v218, v218, v21
  v_mul_f32 v219, v219, v21
  v_mul_f32 v240, v240, v21
  v_mul_f32 v241, v241, v21
  v_mul_f32 v242, v242, v21
  v_mul_f32 v243, v243, v21
  v_mul_f32 v132, v132, v22
  v_mul_f32 v133, v133, v22
  v_mul_f32 v134, v134, v22
  v_mul_f32 v135, v135, v22
  v_mul_f32 v140, v140, v22
  v_mul_f32 v141, v141, v22
  v_mul_f32 v142, v142, v22
  v_mul_f32 v143, v143, v22
  v_mul_f32 v148, v148, v22
  v_mul_f32 v149, v149, v22
  v_mul_f32 v150, v150, v22
  v_mul_f32 v151, v151, v22
  v_mul_f32 v156, v156, v22
  v_mul_f32 v157, v157, v22
  v_mul_f32 v158, v158, v22
  v_mul_f32 v159, v159, v22
  v_mul_f32 v164, v164, v22
  v_mul_f32 v165, v165, v22
  v_mul_f32 v166, v166, v22
  v_mul_f32 v167, v167, v22
  v_mul_f32 v172, v172, v22
  v_mul_f32 v173, v173, v22
  v_mul_f32 v174, v174, v22
  v_mul_f32 v175, v175, v22
  v_mul_f32 v180, v180, v22
  v_mul_f32 v181, v181, v22
  v_mul_f32 v182, v182, v22
  v_mul_f32 v183, v183, v22
  v_mul_f32 v188, v188, v22
  v_mul_f32 v189, v189, v22
  v_mul_f32 v190, v190, v22
  v_mul_f32 v191, v191, v22
  v_mul_f32 v196, v196, v22
  v_mul_f32 v197, v197, v22
  v_mul_f32 v198, v198, v22
  v_mul_f32 v199, v199, v22
  v_mul_f32 v204, v204, v22
  v_mul_f32 v205, v205, v22
  v_mul_f32 v206, v206, v22
  v_mul_f32 v207, v207, v22
  v_mul_f32 v212, v212, v22
  v_mul_f32 v213, v213, v22
  v_mul_f32 v214, v214, v22
  v_mul_f32 v215, v215, v22
  v_mul_f32 v220, v220, v22
  v_mul_f32 v221, v221, v22
  v_mul_f32 v222, v222, v22
  v_mul_f32 v223, v223, v22
  v_mul_f32 v244, v244, v22
  v_mul_f32 v245, v245, v22
  v_mul_f32 v246, v246, v22
  v_mul_f32 v247, v247, v22
  s_mov_b32 s57, 0
  s_cmp_ge_u32 s41, 15
  s_cbranch_scc1 L_rare2a_retb
  s_branch L_rare2a_reta
L_ikb0_alt:
  s_cmp_lt_u32 s41, 14
  s_cbranch_scc1 L_ikb0_ret
  s_mov_b32 m0, s34
  s_nop 0
  buffer_load_dwordx4 v3, s[12:15], s56 offen nt lds
  s_branch L_ikb0_ret
L_ikb1_alt:
  s_cmp_lt_u32 s41, 14
  s_cbranch_scc1 L_ikb1_ret
  s_add_u32 m0, s34, 896
  s_nop 0
  buffer_load_dwordx4 v3, s[12:15], s56 offen offset:128 nt lds
  s_branch L_ikb1_ret
L_ikb2_alt:
  s_cmp_lt_u32 s41, 14
  s_cbranch_scc1 L_ikb2_ret
  s_add_u32 m0, s34, 1792
  s_nop 0
  buffer_load_dwordx4 v3, s[12:15], s56 offen offset:256 nt lds
  s_add_u32 s56, s56, 12288
  s_add_u32 s34, s34, 24576
  s_cmp_eq_u32 s34, s58
  s_cselect_b32 s34, s33, s34
  s_branch L_ikb2_ret
L_ivb0_alt:
  s_cmp_lt_u32 s41, 14
  s_cbranch_scc1 L_ivb0_ret
  s_add_u32 m0, s39, 49152
  s_add_u32 s45, s43, 0
  buffer_load_dwordx4 v4, s[20:23], s45 offen  lds
  s_branch L_ivb0_ret
L_ivb1_alt:
  s_cmp_lt_u32 s41, 14
  s_cbranch_scc1 L_ivb1_ret
  s_add_u32 m0, s39, 53248
  s_add_u32 s45, s43, 40960
  buffer_load_dwordx4 v4, s[20:23], s45 offen  lds
  s_branch L_ivb1_ret
L_ivb2_alt:
  s_cmp_lt_u32 s41, 14
  s_cbranch_scc1 L_ivb2_ret
  s_add_u32 m0, s39, 57344
  s_add_u32 s45, s43, 81920
  buffer_load_dwordx4 v4, s[20:23], s45 offen  lds
  s_branch L_ivb2_ret
L_rare1b:
  v_mov_b32 v25, v23
  s_nop 1
  v_permlane32_swap_b32 v23, v25
  v_max_f32 v23, v23, v25
  v_mov_b32 v25, v23
  s_nop 1
  v_permlane16_swap_b32 v23, v25
  v_max_f32 v23, v23, v25
  v_max_f32 v23, 0, v23
  v_exp_f32 v21, -v23
  v_sub_f32 v248, v248, v23
  v_sub_f32 v249, v249, v23
  v_sub_f32 v250, v250, v23
  v_sub_f32 v251, v251, v23
  v_sub_f32 v56, v56, v23
  v_sub_f32 v57, v57, v23
  v_sub_f32 v58, v58, v23
  v_sub_f32 v59, v59, v23
  v_sub_f32 v60, v60, v23
  v_sub_f32 v61, v61, v23
  v_sub_f32 v62, v62, v23
  v_sub_f32 v63, v63, v23
  s_mov_b32 s57, 1
  s_branch L_rare1b_ret
L_rare2b:
  s_nop 7
  v_mul_f32 v128, v128, v21
  v_mul_f32 v129, v129, v21
  v_mul_f32 v130, v130, v21
  v_mul_f32 v131, v131, v21
  v_mul_f32 v136, v136, v21
  v_mul_f32 v137, v137, v21
  v_mul_f32 v138, v138, v21
  v_mul_f32 v139, v139, v21
  v_mul_f32 v144, v144, v21
  v_mul_f32 v145, v145, v21
  v_mul_f32 v146, v146, v21
  v_mul_f32 v147, v147, v21
  v_mul_f32 v152, v152, v21
  v_mul_f32 v153, v153, v21
  v_mul_f32 v154, v154, v21
  v_mul_f32 v155, v155, v21
  v_mul_f32 v160, v160, v21
  v_mul_f32 v161, v161, v21
  v_mul_f32 v162, v162, v21
  v_mul_f32 v163, v163, v21
  v_mul_f32 v168, v168, v21
  v_mul_f32 v169, v169, v21
  v_mul_f32 v170, v170, v21
  v_mul_f32 v171, v171, v21
  v_mul_f32 v176, v176, v21
  v_mul_f32 v177, v177, v21
  v_mul_f32 v178, v178, v21
  v_mul_f32 v179, v179, v21
  v_mul_f32 v184, v184, v21
  v_mul_f32 v185, v185, v21
  v_mul_f32 v186, v186, v21
  v_mul_f32 v187, v187, v21
  v_mul_f32 v192, v192, v21
  v_mul_f32 v193, v193, v21
  v_mul_f32 v194, v194, v21
  v_mul_f32 v195, v195, v21
  v_mul_f32 v200, v200, v21
  v_mul_f32 v201, v201, v21
  v_mul_f32 v202, v202, v21
  v_mul_f32 v203, v203, v21
  v_mul_f32 v208, v208, v21
  v_mul_f32 v209, v209, v21
  v_mul_f32 v210, v210, v21
  v_mul_f32 v211, v211, v21
  v_mul_f32 v216, v216, v21
  v_mul_f32 v217, v217, v21
  v_mul_f32 v218, v218, v21
  v_mul_f32 v219, v219, v21
  v_mul_f32 v240, v240, v21
  v_mul_f32 v241, v241, v21
  v_mul_f32 v242, v242, v21
  v_mul_f32 v243, v243, v21
  s_mov_b32 s57, 0
  s_cmp_ge_u32 s41, 15
  s_cbranch_scc1 L_rare2b_retb
  s_branch L_rare2b_reta
.section .rodata,"a"
.p2align 6
.amdhsa_kernel standalone__mha_block_cached__near_ridge_kernel
  .amdhsa_next_free_vgpr 256
  .amdhsa_next_free_sgpr 94
  .amdhsa_accum_offset 256
  .amdhsa_group_segment_fixed_size 0
  .amdhsa_kernarg_size 64
  .amdhsa_user_sgpr_count 2
  .amdhsa_user_sgpr_kernarg_segment_ptr 1
  .amdhsa_system_sgpr_workgroup_id_x 1
.end_amdhsa_kernel
```
